```python
import torch

def _softmax(x, axis=-1):
    return torch.softmax(x, dim=axis)
def _gelu(x):
    return torch.nn.functional.gelu(x, approximate="tanh")
def _silu(x):
    return torch.nn.functional.silu(x)
def _sigmoid(x):
    return torch.sigmoid(x)
def _layernorm(x, axis=-1, eps=1e-5):
    m = x.mean(dim=axis, keepdim=True)
    v = x.var(dim=axis, keepdim=True, unbiased=False)
    return (x - m) / torch.sqrt(v + eps)
def _scatter_add(tgt, idx, src, axis=0):
    return tgt.clone().index_add_(axis, idx, src)
def _segment_sum(src, seg, n):
    out = torch.zeros((n,) + src.shape[1:], dtype=src.dtype)
    return out.index_add_(0, seg, src)
def _pad(x, pw):
    flat = tuple(v for pair in reversed(pw) for v in pair)
    return torch.nn.functional.pad(x, flat)

kernel_name = 'sequential_preLN__spectral_gfnet__glu_gated_reglu__prompt'

def setup_inputs():

    _w = (lambda a: (lambda t: t.to(torch.bfloat16) if t.is_floating_point() else t)(torch.as_tensor(a)))
    def _A_setup():
        B, S, D = 1, 2048, 512
        Df = D // 2 + 1
        return {
            "x": _w((lambda *s: torch.randn(*s, dtype=torch.bfloat16) * 0.05)(B, S, D)),
            "w_r": _w((lambda *s: torch.randn(*s, dtype=torch.bfloat16) * 0.4)(S, Df) * 0.02),
            "w_i": _w((lambda *s: torch.randn(*s, dtype=torch.bfloat16) * 0.4)(S, Df) * 0.02),
        }
    _A_in = _A_setup()

    def _B_setup():
        B, S, D, F = 1, 2048, 512, 1792
        return {
            "x": _w((lambda *s: torch.randn(*s, dtype=torch.bfloat16) * 0.05)(B, S, D)),
            "W_gate": _w((lambda *s: torch.randn(*s, dtype=torch.bfloat16) * 0.2)(D, F) * (2.0 / D) ** 0.5),
            "W_up": _w((lambda *s: torch.randn(*s, dtype=torch.bfloat16) * 0.2)(D, F) * (2.0 / D) ** 0.5),
            "W_down": _w((lambda *s: torch.randn(*s, dtype=torch.bfloat16) * 0.2)(F, D) * (1.0 / F) ** 0.5),
        }
    _B_in = _B_setup()

    return {
        "A_x": _A_in["x"],
        "A_w_r": _A_in["w_r"],
        "A_w_i": _A_in["w_i"],
        "B_x": _B_in["x"],
        "B_W_gate": _B_in["W_gate"],
        "B_W_up": _B_in["W_up"],
        "B_W_down": _B_in["W_down"],
    }

def reference(A_x, A_w_r, A_w_i, B_x, B_W_gate, B_W_up, B_W_down):
    def _A_ref(x, w_r, w_i):
        B, S, D = x.shape
        X = (lambda x, axes=(-2,-1): torch.fft.rfft2(x.float(), dim=axes))(x, axes=(-2, -1))
        W = w_r + 1j * w_i
        X = X * W
        y = (lambda x, s, axes=(-2,-1): torch.fft.irfft2(x, s=s, dim=axes).to(torch.bfloat16))(X, (S, D), axes=(-2, -1))
        return y

    def _B_ref(x, W_gate, W_up, W_down):
        gate = torch.einsum("bsd,df->bsf", x, W_gate)
        up = torch.einsum("bsd,df->bsf", x, W_up)
        gate = gate * (lambda x, dt: x.to(dt))(gate > 0, gate.dtype)
        h = gate * up
        return torch.einsum("bsf,fd->bsd", h, W_down)

    x = A_x
    h = x + _A_ref(_layernorm(x, axis=-1), A_w_r, A_w_i)
    h2 = h + _B_ref(_layernorm(h, axis=-1), B_W_gate, B_W_up, B_W_down)
    return h2
```

```asm
; @launch kernel=ka_kernel grid=(256,1,1) block=(512,1,1) lds=16384
; @launch kernel=kb_kernel grid=(256,1,1) block=(512,1,1) lds=49152
; @launch kernel=sequential_preLN__spectral_gfnet__glu_gated_reglu__prompt_kernel grid=(256,1,1) block=(512,1,1) lds=163840
.amdgcn_target "amdgcn-amd-amdhsa--gfx950"

.text
.globl ka_kernel
.p2align 8
.type ka_kernel,@function
ka_kernel:
    s_cmp_ge_u32 s2, 256
    s_cbranch_scc1 A_done
    v_and_b32 v3, 255, v0
    s_getpc_b64 s[18:19]
Lcp1:
    s_add_u32 s18, s18, A_pf0-Lcp1
    s_addc_u32 s19, s19, 0
    v_lshlrev_b32 v1, 6, v3
    v_min_u32 v1, A_done-A_pf0-4, v1
    global_load_dword v2, v1, s[18:19]
A_pf0:
    s_load_dwordx2 s[4:5], s[0:1], 0
    s_load_dwordx2 s[10:11], s[0:1], 72
    s_load_dwordx2 s[6:7], s[0:1], 8
    s_load_dwordx2 s[8:9], s[0:1], 16
    s_load_dwordx2 s[12:13], s[0:1], 32
    v_lshrrev_b32 v6, 6, v0
    s_nop 0
    v_readfirstlane_b32 s14, v6
    v_and_b32 v7, 63, v0
    v_and_b32 v5, 15, v0
    v_lshrrev_b32 v6, 4, v7
    s_mov_b32 s20, 0
    s_cmp_lt_u32 s14, 4
    s_cbranch_scc1 A_main
    s_and_b32 s54, s14, 3
    v_and_b32 v180, 255, v0
    s_and_b32 s49, s2, 3
    s_bfe_u32 s15, s2, 0x10004
    s_lshl_b32 s48, s15, 10
    s_bfe_u32 s15, s2, 0x10005
    s_lshl_b32 s15, s15, 9
    s_add_u32 s48, s48, s15
    s_bfe_u32 s15, s2, 0x20002
    s_lshl_b32 s15, s15, 7
    s_add_u32 s48, s48, s15
    s_lshr_b32 s15, s2, 6
    s_lshl_b32 s15, s15, 3
    s_add_u32 s48, s48, s15
    s_lshl_b32 s15, s54, 1
    s_add_u32 s48, s48, s15
    s_mul_i32 s40, s48, 514
    s_lshl_b32 s15, s49, 7
    s_add_u32 s40, s40, s15
    s_add_u32 s41, s40, 16448
    s_add_u32 s42, s40, 32896
    s_add_u32 s43, s40, 49344
    s_add_u32 s44, s40, 514
    s_add_u32 s45, s40, 16962
    s_add_u32 s46, s40, 33410
    s_add_u32 s47, s40, 49858
    v_lshlrev_b32 v181, 1, v7
    v_add_u32 v181, 2, v181
    s_waitcnt lgkmcnt(0)
    s_mov_b32 s28, s6
    s_mov_b32 s29, s7
    s_and_b32 s29, s29, 0xffff
    s_mov_b32 s30, 0x101000
    s_mov_b32 s31, 0x20000
    s_mov_b32 s32, s8
    s_mov_b32 s33, s9
    s_and_b32 s33, s33, 0xffff
    s_mov_b32 s34, 0x101000
    s_mov_b32 s35, 0x20000
    buffer_load_ushort v184, v181, s[28:31], s40 offen
    buffer_load_ushort v192, v181, s[32:35], s40 offen
    buffer_load_ushort v185, v181, s[28:31], s41 offen
    buffer_load_ushort v193, v181, s[32:35], s41 offen
    buffer_load_ushort v186, v181, s[28:31], s42 offen
    buffer_load_ushort v194, v181, s[32:35], s42 offen
    buffer_load_ushort v187, v181, s[28:31], s43 offen
    buffer_load_ushort v195, v181, s[32:35], s43 offen
    buffer_load_ushort v188, v181, s[28:31], s44 offen
    buffer_load_ushort v196, v181, s[32:35], s44 offen
    buffer_load_ushort v189, v181, s[28:31], s45 offen
    buffer_load_ushort v197, v181, s[32:35], s45 offen
    buffer_load_ushort v190, v181, s[28:31], s46 offen
    buffer_load_ushort v198, v181, s[32:35], s46 offen
    buffer_load_ushort v191, v181, s[28:31], s47 offen
    buffer_load_ushort v199, v181, s[32:35], s47 offen
    s_branch A_helper2
A_main:
    s_and_b32 s15, s2, 7
    s_lshl_b32 s15, s15, 5
    s_lshr_b32 s16, s2, 3
    s_add_u32 s36, s15, s16
    s_lshr_b32 s15, s36, 7
    s_lshl_b32 s37, s15, 9
    s_bfe_u32 s15, s36, 0x20004
    s_lshl_b32 s15, s15, 7
    s_add_u32 s37, s37, s15
    s_lshl_b32 s15, s14, 5
    s_add_u32 s37, s37, s15
    s_bfe_u32 s15, s36, 0x10006
    s_lshl_b32 s15, s15, 4
    s_add_u32 s37, s37, s15
    s_and_b32 s15, s36, 15
    s_add_u32 s37, s37, s15
    s_lshl_b32 s37, s37, 11
    v_lshlrev_b32 v10, 8, v6
    v_lshl_add_u32 v10, v5, 2, v10
    s_waitcnt lgkmcnt(0)
    s_mov_b32 s28, s4
    s_mov_b32 s29, s5
    s_and_b32 s29, s29, 0xffff
    s_mov_b32 s30, 0x200000
    s_mov_b32 s31, 0x20000
    buffer_load_dword v12, v10, s[28:31], s37 offen offset:0
    buffer_load_dword v13, v10, s[28:31], s37 offen offset:64
    buffer_load_dword v14, v10, s[28:31], s37 offen offset:128
    buffer_load_dword v15, v10, s[28:31], s37 offen offset:192
    buffer_load_dword v16, v10, s[28:31], s37 offen offset:1024
    buffer_load_dword v17, v10, s[28:31], s37 offen offset:1088
    buffer_load_dword v18, v10, s[28:31], s37 offen offset:1152
    buffer_load_dword v19, v10, s[28:31], s37 offen offset:1216
    s_mov_b32 s32, s10
    s_mov_b32 s33, s11
    s_and_b32 s33, s33, 0xffff
    s_mov_b32 s34, 0x200000
    s_mov_b32 s35, 0x20000
    v_cvt_f32_u32 v8, v5
    v_cvt_f32_u32 v9, v6
    v_mul_f32 v21, 0x3d800000, v8
    v_mul_f32 v32, v8, v9
    v_mul_f32 v32, 0x3e800000, v32
    v_add_f32 v33, v32, v21
    v_add_f32 v34, v33, v21
    v_add_f32 v35, v34, v21
    v_cos_f32 v40, v32
    v_sin_f32 v41, v32
    v_cos_f32 v42, v33
    v_sin_f32 v43, v33
    v_cos_f32 v44, v34
    v_sin_f32 v45, v34
    v_cos_f32 v46, v35
    v_sin_f32 v47, v35
    v_cvt_pk_bf16_f32 v24, v40, v41
    v_cvt_pk_bf16_f32 v28, -v41, v40
    v_cvt_pk_bf16_f32 v25, v42, v43
    v_cvt_pk_bf16_f32 v29, -v43, v42
    v_cvt_pk_bf16_f32 v26, v44, v45
    v_cvt_pk_bf16_f32 v30, -v45, v44
    v_cvt_pk_bf16_f32 v27, v46, v47
    v_cvt_pk_bf16_f32 v31, -v47, v46
    v_mul_f32 v21, 0x3b000000, v8
    v_mul_f32 v64, 0x41000000, v9
    v_mul_f32 v32, v64, v21
    v_add_f32 v33, v32, v21
    v_add_f32 v34, v33, v21
    v_add_f32 v35, v34, v21
    v_add_f32 v36, v35, v21
    v_add_f32 v37, v36, v21
    v_add_f32 v38, v37, v21
    v_add_f32 v39, v38, v21
    v_cos_f32 v48, v32
    v_sin_f32 v56, v32
    v_cos_f32 v49, v34
    v_sin_f32 v57, v34
    v_cos_f32 v50, v36
    v_sin_f32 v58, v36
    v_cos_f32 v51, v38
    v_sin_f32 v59, v38
    v_cos_f32 v52, v33
    v_sin_f32 v60, v33
    v_cos_f32 v53, v35
    v_sin_f32 v61, v35
    v_cos_f32 v54, v37
    v_sin_f32 v62, v37
    v_cos_f32 v55, v39
    v_sin_f32 v63, v39
    v_mul_f32 v21, 0x3d000000, v8
    v_mul_f32 v32, v64, v21
    v_add_f32 v33, v32, v21
    v_add_f32 v34, v33, v21
    v_add_f32 v35, v34, v21
    v_add_f32 v36, v35, v21
    v_add_f32 v37, v36, v21
    v_add_f32 v38, v37, v21
    v_add_f32 v39, v38, v21
    v_cos_f32 v40, v32
    v_sin_f32 v41, v32
    v_cos_f32 v42, v34
    v_sin_f32 v43, v34
    v_cos_f32 v44, v36
    v_sin_f32 v45, v36
    v_cos_f32 v46, v38
    v_sin_f32 v47, v38
    v_cvt_pk_bf16_f32 v68, v40, v41
    v_cvt_pk_bf16_f32 v72, -v41, v40
    v_cvt_pk_bf16_f32 v69, v42, v43
    v_cvt_pk_bf16_f32 v73, -v43, v42
    v_cvt_pk_bf16_f32 v70, v44, v45
    v_cvt_pk_bf16_f32 v74, -v45, v44
    v_cvt_pk_bf16_f32 v71, v46, v47
    v_cvt_pk_bf16_f32 v75, -v47, v46
    v_cos_f32 v40, v33
    v_sin_f32 v41, v33
    v_cos_f32 v42, v35
    v_sin_f32 v43, v35
    v_cos_f32 v44, v37
    v_sin_f32 v45, v37
    v_cos_f32 v46, v39
    v_sin_f32 v47, v39
    v_cvt_pk_bf16_f32 v76, v40, v41
    v_cvt_pk_bf16_f32 v80, -v41, v40
    v_cvt_pk_bf16_f32 v77, v42, v43
    v_cvt_pk_bf16_f32 v81, -v43, v42
    v_cvt_pk_bf16_f32 v78, v44, v45
    v_cvt_pk_bf16_f32 v82, -v45, v44
    v_cvt_pk_bf16_f32 v79, v46, v47
    v_cvt_pk_bf16_f32 v83, -v47, v46
    v_xor_b32 v84, 0x80008000, v76
    v_xor_b32 v85, 0x80008000, v77
    v_xor_b32 v86, 0x80008000, v78
    v_xor_b32 v87, 0x80008000, v79
    v_xor_b32 v88, 0x80008000, v80
    v_xor_b32 v89, 0x80008000, v81
    v_xor_b32 v90, 0x80008000, v82
    v_xor_b32 v91, 0x80008000, v83
    v_lshlrev_b32 v92, 8, v6
    v_lshl_add_u32 v92, v5, 2, v92
    s_lshl_b32 s15, s14, 11
    v_add_u32 v92, s15, v92
    v_lshrrev_b32 v3, 1, v0
    v_sub_u32 v4, 512, v3
    v_cmp_eq_u32 vcc, 0, v3
    v_mov_b32 v93, 256
    s_nop 0
    v_cndmask_b32 v4, v4, v93, vcc
    v_and_b32 v93, 1, v0
    v_cmp_eq_u32 vcc, 1, v93
    s_nop 1
    v_cndmask_b32 v3, v3, v4, vcc
    v_lshlrev_b32 v93, 2, v3
    v_lshrrev_b32 v3, 1, v0
    v_add_u32 v3, 128, v3
    v_sub_u32 v4, 512, v3
    v_and_b32 v94, 1, v0
    v_cmp_eq_u32 vcc, 1, v94
    s_nop 1
    v_cndmask_b32 v3, v3, v4, vcc
    v_lshlrev_b32 v94, 2, v3
    v_lshrrev_b32 v95, 1, v0
    v_lshlrev_b32 v95, 13, v95
    v_and_b32 v3, 1, v0
    v_lshl_add_u32 v95, v3, 4, v95
    s_lshl_b32 s38, s36, 5
    s_add_u32 s39, s38, 1048576
    s_waitcnt vmcnt(0)
A_blk:
    v_lshlrev_b32 v96, 16, v12
    v_lshlrev_b32 v97, 16, v16
    v_and_b32 v98, 0xffff0000, v12
    v_and_b32 v99, 0xffff0000, v16
    v_lshlrev_b32 v100, 16, v13
    v_lshlrev_b32 v101, 16, v17
    v_and_b32 v102, 0xffff0000, v13
    v_and_b32 v103, 0xffff0000, v17
    v_lshlrev_b32 v104, 16, v14
    v_lshlrev_b32 v105, 16, v18
    v_and_b32 v106, 0xffff0000, v14
    v_and_b32 v107, 0xffff0000, v18
    v_lshlrev_b32 v108, 16, v15
    v_lshlrev_b32 v109, 16, v19
    v_and_b32 v110, 0xffff0000, v15
    v_and_b32 v111, 0xffff0000, v19
    v_readfirstlane_b32 s22, v96
    v_readfirstlane_b32 s23, v97
    s_nop 1
    v_pk_add_f32 v[96:97], v[96:97], s[22:23] neg_lo:[0,1] neg_hi:[0,1]
    v_pk_add_f32 v[98:99], v[98:99], s[22:23] neg_lo:[0,1] neg_hi:[0,1]
    v_pk_add_f32 v[100:101], v[100:101], s[22:23] neg_lo:[0,1] neg_hi:[0,1]
    v_pk_add_f32 v[102:103], v[102:103], s[22:23] neg_lo:[0,1] neg_hi:[0,1]
    v_pk_add_f32 v[104:105], v[104:105], s[22:23] neg_lo:[0,1] neg_hi:[0,1]
    v_pk_add_f32 v[106:107], v[106:107], s[22:23] neg_lo:[0,1] neg_hi:[0,1]
    v_pk_add_f32 v[108:109], v[108:109], s[22:23] neg_lo:[0,1] neg_hi:[0,1]
    v_pk_add_f32 v[110:111], v[110:111], s[22:23] neg_lo:[0,1] neg_hi:[0,1]
    v_pk_add_f32 v[112:113], v[96:97], v[98:99]
    v_pk_mul_f32 v[114:115], v[96:97], v[96:97]
    v_pk_add_f32 v[116:117], v[100:101], v[102:103]
    v_pk_mul_f32 v[118:119], v[98:99], v[98:99]
    v_pk_add_f32 v[112:113], v[112:113], v[104:105]
    v_pk_fma_f32 v[114:115], v[100:101], v[100:101], v[114:115]
    v_pk_add_f32 v[116:117], v[116:117], v[106:107]
    v_pk_fma_f32 v[118:119], v[102:103], v[102:103], v[118:119]
    v_pk_add_f32 v[112:113], v[112:113], v[108:109]
    v_pk_fma_f32 v[114:115], v[104:105], v[104:105], v[114:115]
    v_pk_add_f32 v[116:117], v[116:117], v[110:111]
    v_pk_fma_f32 v[118:119], v[106:107], v[106:107], v[118:119]
    v_pk_fma_f32 v[114:115], v[108:109], v[108:109], v[114:115]
    v_pk_add_f32 v[112:113], v[112:113], v[116:117]
    v_pk_fma_f32 v[118:119], v[110:111], v[110:111], v[118:119]
    v_pk_add_f32 v[114:115], v[114:115], v[118:119]
    v_add_f32_dpp v112, v112, v112 row_ror:8 row_mask:0xf bank_mask:0xf
    v_add_f32_dpp v113, v113, v113 row_ror:8 row_mask:0xf bank_mask:0xf
    v_add_f32_dpp v114, v114, v114 row_ror:8 row_mask:0xf bank_mask:0xf
    v_add_f32_dpp v115, v115, v115 row_ror:8 row_mask:0xf bank_mask:0xf
    v_add_f32_dpp v112, v112, v112 row_ror:4 row_mask:0xf bank_mask:0xf
    v_add_f32_dpp v113, v113, v113 row_ror:4 row_mask:0xf bank_mask:0xf
    v_add_f32_dpp v114, v114, v114 row_ror:4 row_mask:0xf bank_mask:0xf
    v_add_f32_dpp v115, v115, v115 row_ror:4 row_mask:0xf bank_mask:0xf
    v_add_f32_dpp v112, v112, v112 row_ror:2 row_mask:0xf bank_mask:0xf
    v_add_f32_dpp v113, v113, v113 row_ror:2 row_mask:0xf bank_mask:0xf
    v_add_f32_dpp v114, v114, v114 row_ror:2 row_mask:0xf bank_mask:0xf
    v_add_f32_dpp v115, v115, v115 row_ror:2 row_mask:0xf bank_mask:0xf
    v_add_f32_dpp v112, v112, v112 row_ror:1 row_mask:0xf bank_mask:0xf
    v_add_f32_dpp v113, v113, v113 row_ror:1 row_mask:0xf bank_mask:0xf
    v_add_f32_dpp v114, v114, v114 row_ror:1 row_mask:0xf bank_mask:0xf
    v_add_f32_dpp v115, v115, v115 row_ror:1 row_mask:0xf bank_mask:0xf
    v_add_f32_dpp v112, v112, v112 row_bcast:15 row_mask:0xa bank_mask:0xf
    v_add_f32_dpp v113, v113, v113 row_bcast:15 row_mask:0xa bank_mask:0xf
    v_add_f32_dpp v114, v114, v114 row_bcast:15 row_mask:0xa bank_mask:0xf
    v_add_f32_dpp v115, v115, v115 row_bcast:15 row_mask:0xa bank_mask:0xf
    v_add_f32_dpp v112, v112, v112 row_bcast:31 row_mask:0xc bank_mask:0xf
    v_add_f32_dpp v113, v113, v113 row_bcast:31 row_mask:0xc bank_mask:0xf
    v_add_f32_dpp v114, v114, v114 row_bcast:31 row_mask:0xc bank_mask:0xf
    v_add_f32_dpp v115, v115, v115 row_bcast:31 row_mask:0xc bank_mask:0xf
    v_mov_b32 v3, 0x3727c5ac
    v_mov_b32 v4, 0x3b000000
    v_mul_f32 v112, v4, v112
    v_mul_f32 v113, v4, v113
    v_fma_f32 v114, v114, v4, v3
    v_fma_f32 v115, v115, v4, v3
    v_fma_f32 v114, -v112, v112, v114
    v_fma_f32 v115, -v113, v113, v115
    v_max_f32 v114, v3, v114
    v_max_f32 v115, v3, v115
    v_rsq_f32 v114, v114
    v_rsq_f32 v115, v115
    v_mul_f32 v112, v112, v114
    v_mul_f32 v113, v113, v115
    v_readlane_b32 s24, v114, 63
    v_readlane_b32 s25, v115, 63
    v_readlane_b32 s22, v112, 63
    v_readlane_b32 s23, v113, 63
    s_nop 0
    v_mov_b32 v116, s22
    v_mov_b32 v117, s23
    v_pk_fma_f32 v[96:97], v[96:97], s[24:25], v[116:117] neg_lo:[0,0,1] neg_hi:[0,0,1]
    v_pk_fma_f32 v[98:99], v[98:99], s[24:25], v[116:117] neg_lo:[0,0,1] neg_hi:[0,0,1]
    v_pk_fma_f32 v[100:101], v[100:101], s[24:25], v[116:117] neg_lo:[0,0,1] neg_hi:[0,0,1]
    v_pk_fma_f32 v[102:103], v[102:103], s[24:25], v[116:117] neg_lo:[0,0,1] neg_hi:[0,0,1]
    v_pk_fma_f32 v[104:105], v[104:105], s[24:25], v[116:117] neg_lo:[0,0,1] neg_hi:[0,0,1]
    v_pk_fma_f32 v[106:107], v[106:107], s[24:25], v[116:117] neg_lo:[0,0,1] neg_hi:[0,0,1]
    v_pk_fma_f32 v[108:109], v[108:109], s[24:25], v[116:117] neg_lo:[0,0,1] neg_hi:[0,0,1]
    v_pk_fma_f32 v[110:111], v[110:111], s[24:25], v[116:117] neg_lo:[0,0,1] neg_hi:[0,0,1]
    v_cvt_pk_bf16_f32 v120, v96, v97
    v_cvt_pk_bf16_f32 v121, v100, v101
    v_cvt_pk_bf16_f32 v122, v104, v105
    v_cvt_pk_bf16_f32 v123, v108, v109
    v_cvt_pk_bf16_f32 v124, v98, v99
    v_cvt_pk_bf16_f32 v125, v102, v103
    v_cvt_pk_bf16_f32 v126, v106, v107
    v_cvt_pk_bf16_f32 v127, v110, v111
    v_mfma_f32_16x16x32_bf16 v[128:131], v[120:123], v[24:27], 0
    v_mfma_f32_16x16x32_bf16 v[132:135], v[120:123], v[28:31], 0
    v_mfma_f32_16x16x32_bf16 v[136:139], v[124:127], v[24:27], 0
    v_mfma_f32_16x16x32_bf16 v[140:143], v[124:127], v[28:31], 0
    s_nop 4
    v_pk_mul_f32 v[144:145], v[128:129], v[48:49]
    v_pk_mul_f32 v[148:149], v[132:133], v[48:49]
    v_pk_fma_f32 v[144:145], v[132:133], v[56:57], v[144:145]
    v_pk_fma_f32 v[148:149], v[128:129], v[56:57], v[148:149] neg_lo:[1,0,0] neg_hi:[1,0,0]
    v_pk_mul_f32 v[146:147], v[130:131], v[50:51]
    v_pk_mul_f32 v[150:151], v[134:135], v[50:51]
    v_pk_fma_f32 v[146:147], v[134:135], v[58:59], v[146:147]
    v_pk_fma_f32 v[150:151], v[130:131], v[58:59], v[150:151] neg_lo:[1,0,0] neg_hi:[1,0,0]
    v_cvt_pk_bf16_f32 v120, v144, v148
    v_cvt_pk_bf16_f32 v121, v145, v149
    v_cvt_pk_bf16_f32 v122, v146, v150
    v_cvt_pk_bf16_f32 v123, v147, v151
    v_pk_mul_f32 v[152:153], v[136:137], v[52:53]
    v_pk_mul_f32 v[156:157], v[140:141], v[52:53]
    v_pk_fma_f32 v[152:153], v[140:141], v[60:61], v[152:153]
    v_pk_fma_f32 v[156:157], v[136:137], v[60:61], v[156:157] neg_lo:[1,0,0] neg_hi:[1,0,0]
    v_pk_mul_f32 v[154:155], v[138:139], v[54:55]
    v_pk_mul_f32 v[158:159], v[142:143], v[54:55]
    v_pk_fma_f32 v[154:155], v[142:143], v[62:63], v[154:155]
    v_pk_fma_f32 v[158:159], v[138:139], v[62:63], v[158:159] neg_lo:[1,0,0] neg_hi:[1,0,0]
    v_cvt_pk_bf16_f32 v124, v152, v156
    v_cvt_pk_bf16_f32 v125, v153, v157
    v_cvt_pk_bf16_f32 v126, v154, v158
    v_cvt_pk_bf16_f32 v127, v155, v159
    v_mfma_f32_16x16x32_bf16 v[128:131], v[68:71], v[120:123], 0
    v_mfma_f32_16x16x32_bf16 v[132:135], v[72:75], v[120:123], 0
    v_mfma_f32_16x16x32_bf16 v[136:139], v[68:71], v[120:123], 0
    v_mfma_f32_16x16x32_bf16 v[140:143], v[72:75], v[120:123], 0
    v_mfma_f32_16x16x32_bf16 v[128:131], v[76:79], v[124:127], v[128:131]
    v_mfma_f32_16x16x32_bf16 v[132:135], v[80:83], v[124:127], v[132:135]
    v_mfma_f32_16x16x32_bf16 v[136:139], v[84:87], v[124:127], v[136:139]
    v_mfma_f32_16x16x32_bf16 v[140:143], v[88:91], v[124:127], v[140:143]
    s_nop 5
    v_cvt_pk_bf16_f32 v160, v128, v132
    v_cvt_pk_bf16_f32 v161, v129, v133
    v_cvt_pk_bf16_f32 v162, v130, v134
    v_cvt_pk_bf16_f32 v163, v131, v135
    v_cvt_pk_bf16_f32 v164, v136, v140
    v_cvt_pk_bf16_f32 v165, v137, v141
    v_cvt_pk_bf16_f32 v166, v138, v142
    v_cvt_pk_bf16_f32 v167, v139, v143
    ds_write_b32 v92, v160 offset:0
    ds_write_b32 v92, v161 offset:64
    ds_write_b32 v92, v162 offset:128
    ds_write_b32 v92, v163 offset:192
    ds_write_b32 v92, v164 offset:1024
    ds_write_b32 v92, v165 offset:1088
    ds_write_b32 v92, v166 offset:1152
    ds_write_b32 v92, v167 offset:1216
    s_waitcnt lgkmcnt(0)
    s_barrier
    ds_read2st64_b32 v[168:169], v93 offset0:0 offset1:8
    ds_read2st64_b32 v[170:171], v93 offset0:16 offset1:24
    ds_read2st64_b32 v[172:173], v94 offset0:0 offset1:8
    ds_read2st64_b32 v[174:175], v94 offset0:16 offset1:24
    s_waitcnt lgkmcnt(2)
    buffer_store_dwordx4 v[168:171], v95, s[32:35], s38 offen
    s_waitcnt lgkmcnt(0)
    buffer_store_dwordx4 v[172:175], v95, s[32:35], s39 offen
    s_branch A_done
A_helper2:
    v_and_b32 v3, 3, v7
    v_lshlrev_b32 v3, 5, v3
    v_bfe_u32 v4, v7, 2, 1
    v_add3_u32 v3, v3, v4, s48
    v_sub_u32 v205, 0x800, v3
    v_and_b32 v205, 0x7ff, v205
    v_mul_u32_u24 v204, 514, v3
    v_mul_u32_u24 v205, 514, v205
    s_lshl_b32 s15, s54, 1
    v_add_u32 v4, s15, v4
    v_xor_b32 v4, 7, v4
    v_lshlrev_b32 v4, 4, v4
    v_and_b32 v3, 3, v7
    v_lshl_add_u32 v206, v3, 2, v4
    v_add_u32 v206, 16256, v206
    v_and_b32 v3, 7, v7
    s_lshl_b32 s15, s54, 1
    v_xor_b32 v3, s15, v3
    v_lshlrev_b32 v3, 4, v3
    v_lshl_add_u32 v207, v7, 7, v3
    v_xor_b32 v208, 16, v207
    v_lshrrev_b32 v3, 3, v180
    v_xor_b32 v4, v3, v180
    v_and_b32 v4, 7, v4
    v_lshlrev_b32 v4, 4, v4
    v_lshl_add_u32 v209, v3, 7, v4
    v_lshlrev_b32 v210, 13, v3
    v_and_b32 v4, 7, v180
    v_lshl_add_u32 v210, v4, 4, v210
    s_lshl_b32 s50, s49, 19
    s_lshr_b32 s15, s2, 2
    s_lshl_b32 s15, s15, 7
    s_add_u32 s50, s50, s15
    s_add_u32 s51, s50, 262144
    s_cmp_eq_u32 s49, 3
    s_cbranch_scc0 A_nospec1
    s_mov_b64 s[52:53], exec
    s_mov_b64 exec, 0xff
    buffer_load_ushort v200, v204, s[28:31], 0 offen offset:512
    buffer_load_ushort v201, v204, s[32:35], 0 offen offset:512
    buffer_load_ushort v202, v205, s[28:31], 0 offen offset:512
    buffer_load_ushort v203, v205, s[32:35], 0 offen offset:512
    s_mov_b64 exec, s[52:53]
A_nospec1:
    s_add_u32 s36, s10, 0x200000
    s_addc_u32 s37, s11, 0
    s_and_b32 s37, s37, 0xffff
    s_mov_b32 s38, 0x200000
    s_mov_b32 s39, 0x20000
    s_mov_b32 s56, s12
    s_mov_b32 s57, s13
    s_and_b32 s57, s57, 0xffff
    s_mov_b32 s58, 0x1c0000
    s_mov_b32 s59, 0x20000
    s_mul_i32 s60, s2, 7168
    s_mul_i32 s61, s54, 1792
    s_add_u32 s60, s60, s61
    v_min_u32 v3, 13, v7
    v_lshlrev_b32 v3, 7, v3
    buffer_load_dword v211, v3, s[56:59], s60 offen
    s_getpc_b64 s[18:19]
Lcp2:
    s_add_u32 s18, s18, kb_kernel-Lcp2
    s_addc_u32 s19, s19, 0
    s_lshr_b32 s15, s2, 3
    s_mul_i32 s15, s15, 1152
    v_min_u32 v1, 17, v7
    v_lshlrev_b32 v1, 6, v1
    v_add_u32 v1, s15, v1
    v_min_u32 v1, F_done-kb_kernel-4, v1
    global_load_dword v2, v1, s[18:19]
    s_waitcnt vmcnt(2)
    v_lshl_or_b32 v184, v192, 16, v184
    v_lshl_or_b32 v185, v193, 16, v185
    v_lshl_or_b32 v186, v194, 16, v186
    v_lshl_or_b32 v187, v195, 16, v187
    v_lshl_or_b32 v188, v196, 16, v188
    v_lshl_or_b32 v189, v197, 16, v189
    v_lshl_or_b32 v190, v198, 16, v190
    v_lshl_or_b32 v191, v199, 16, v191
    ds_write_b128 v207, v[184:187] offset:8192
    ds_write_b128 v208, v[188:191] offset:8192
    s_cmp_eq_u32 s49, 3
    s_cbranch_scc0 A_nospec2
    v_lshlrev_b32 v200, 16, v200
    v_lshlrev_b32 v201, 16, v201
    v_lshlrev_b32 v202, 16, v202
    v_lshlrev_b32 v203, 16, v203
    v_add_f32 v200, v200, v202
    v_sub_f32 v201, v201, v203
    v_mul_f32 v200, 0.5, v200
    v_mul_f32 v201, 0.5, v201
    v_cvt_pk_bf16_f32 v200, v200, v201
    s_mov_b64 exec, 0xff
    ds_write_b32 v206, v200
    s_mov_b64 exec, s[52:53]
A_nospec2:
    s_waitcnt lgkmcnt(0)
    s_barrier
    ds_read_b128 v[212:215], v209 offset:8192
    ds_read_b128 v[216:219], v209 offset:12288
    s_waitcnt lgkmcnt(1)
    buffer_store_dwordx4 v[212:215], v210, s[36:39], s50 offen
    s_waitcnt lgkmcnt(0)
    buffer_store_dwordx4 v[216:219], v210, s[36:39], s51 offen
A_done:
    s_endpgm

.text
.globl kb_kernel
.p2align 8
.type kb_kernel,@function
kb_kernel:
    s_cmp_ge_u32 s2, 256
    s_cbranch_scc1 B_done
    s_load_dwordx2 s[4:5], s[0:1], 72
    s_load_dwordx2 s[6:7], s[0:1], 40
    s_load_dwordx2 s[8:9], s[0:1], 48
    s_load_dwordx2 s[14:15], s[0:1], 32
    v_lshrrev_b32 v2, 6, v0
    s_nop 0
    v_readfirstlane_b32 s10, v2
    v_and_b32 v5, 63, v0
    v_and_b32 v1, 15, v0
    v_lshrrev_b32 v2, 4, v5
    v_and_b32 v6, 7, v0
    s_and_b32 s13, s10, 3
    v_cvt_f32_u32 v3, v1
    v_cvt_f32_u32 v4, v2
    s_lshl_b32 s11, s13, 3
    v_add_u32 v8, s11, v6
    v_cvt_f32_u32 v7, v8
    v_cmp_gt_u32 vcc, 8, v1
    v_mov_b32 v9, 1.0
    v_mul_f32 v11, 4.0, v4
    v_cndmask_b32 v10, -1.0, v9, vcc
    s_mul_i32 s11, s13, 10240
    s_add_u32 s11, s11, 8192
    v_lshlrev_b32 v12, 4, v5
    v_add_u32 v12, s11, v12
    s_cmp_ge_u32 s10, 4
    s_cbranch_scc1 B_helper
    s_add_u32 s34, s2, 1
    s_and_b32 s11, s34, 255
    s_lshl_b32 s28, s11, 13
    s_add_u32 s29, s28, 16
    s_cmp_eq_u32 s34, 256
    s_cselect_b32 s28, s29, s28
    s_add_u32 s35, s28, 4096
    s_add_u32 s36, s29, 4096
    s_lshl_b32 s30, s2, 13
    s_lshl_b32 s11, s10, 11
    s_add_u32 s30, s30, s11
    v_lshlrev_b32 v13, 5, v5
    v_lshlrev_b32 v15, 4, v5
    v_lshlrev_b32 v14, 7, v2
    v_lshl_add_u32 v14, v6, 4, v14
    v_and_b32 v8, 1, v6
    v_mul_u32_u24 v18, 0x8000, v8
    v_cndmask_b32 v16, 0, -1, vcc
    v_lshl_or_b32 v18, v18, 16, v18
    v_not_b32 v17, v16
    v_mul_f32 v24, 0x3d000000, v7
    v_mul_f32 v20, v11, v24
    v_add_f32 v21, v20, v24
    v_add_f32 v22, v21, v24
    v_add_f32 v23, v22, v24
    v_cos_f32 v28, v20
    v_sin_f32 v29, v20
    v_cos_f32 v30, v21
    v_sin_f32 v31, v21
    v_cos_f32 v32, v22
    v_sin_f32 v33, v22
    v_cos_f32 v34, v23
    v_sin_f32 v35, v23
    v_mul_f32 v26, v10, v29
    v_mul_f32 v27, v10, v28
    v_cvt_pk_bf16_f32 v8, v28, v26
    v_cvt_pk_bf16_f32 v9, -v29, v27
    v_and_b32 v36, v16, v8
    v_and_b32 v52, v17, v8
    v_and_b32 v40, v16, v9
    v_and_b32 v56, v17, v9
    v_mul_f32 v26, v10, v31
    v_mul_f32 v27, v10, v30
    v_cvt_pk_bf16_f32 v8, v30, v26
    v_cvt_pk_bf16_f32 v9, -v31, v27
    v_and_b32 v37, v16, v8
    v_and_b32 v53, v17, v8
    v_and_b32 v41, v16, v9
    v_and_b32 v57, v17, v9
    v_mul_f32 v26, v10, v33
    v_mul_f32 v27, v10, v32
    v_cvt_pk_bf16_f32 v8, v32, v26
    v_cvt_pk_bf16_f32 v9, -v33, v27
    v_and_b32 v38, v16, v8
    v_and_b32 v54, v17, v8
    v_and_b32 v42, v16, v9
    v_and_b32 v58, v17, v9
    v_mul_f32 v26, v10, v35
    v_mul_f32 v27, v10, v34
    v_cvt_pk_bf16_f32 v8, v34, v26
    v_cvt_pk_bf16_f32 v9, -v35, v27
    v_and_b32 v39, v16, v8
    v_and_b32 v55, v17, v8
    v_and_b32 v43, v16, v9
    v_and_b32 v59, v17, v9
    s_waitcnt lgkmcnt(0)
    s_mov_b32 s16, s4
    s_mov_b32 s17, s5
    s_and_b32 s17, s17, 0xffff
    s_mov_b32 s18, 0x200000
    s_mov_b32 s19, 0x20000
    s_add_u32 s20, s4, 0x200000
    s_addc_u32 s21, s5, 0
    s_and_b32 s21, s21, 0xffff
    s_mov_b32 s22, 0x200000
    s_mov_b32 s23, 0x20000
    buffer_load_dwordx4 v[68:71], v13, s[16:19], s28 offen offset:0
    buffer_load_dwordx4 v[84:87], v13, s[16:19], s29 offen offset:0
    buffer_load_dwordx4 v[72:75], v13, s[16:19], s28 offen offset:2048
    buffer_load_dwordx4 v[88:91], v13, s[16:19], s29 offen offset:2048
    buffer_load_dwordx4 v[76:79], v13, s[16:19], s35 offen offset:0
    buffer_load_dwordx4 v[92:95], v13, s[16:19], s36 offen offset:0
    buffer_load_dwordx4 v[80:83], v13, s[16:19], s35 offen offset:2048
    buffer_load_dwordx4 v[96:99], v13, s[16:19], s36 offen offset:2048
    buffer_load_dwordx4 v[100:103], v14, s[20:23], s30 offen offset:0
    buffer_load_dwordx4 v[104:107], v14, s[20:23], s30 offen offset:512
    buffer_load_dwordx4 v[108:111], v14, s[20:23], s30 offen offset:1024
    buffer_load_dwordx4 v[112:115], v14, s[20:23], s30 offen offset:1536
    s_add_u32 s24, s4, 0x800000
    s_addc_u32 s25, s5, 0
    s_and_b32 s25, s25, 0xffff
    s_mov_b32 s26, 0x200000
    s_mov_b32 s27, 0x20000
    v_xor_b32 v44, v18, v36
    v_xor_b32 v60, v18, v52
    v_xor_b32 v45, v18, v37
    v_xor_b32 v61, v18, v53
    v_xor_b32 v46, v18, v38
    v_xor_b32 v62, v18, v54
    v_xor_b32 v47, v18, v39
    v_xor_b32 v63, v18, v55
    v_xor_b32 v48, v18, v40
    v_xor_b32 v64, v18, v56
    v_xor_b32 v49, v18, v41
    v_xor_b32 v65, v18, v57
    v_xor_b32 v50, v18, v42
    v_xor_b32 v66, v18, v58
    v_xor_b32 v51, v18, v43
    v_xor_b32 v67, v18, v59
    s_lshr_b32 s11, s10, 1
    s_cmp_eq_u32 s11, 0
    s_cselect_b32 s31, s28, s29
    s_cselect_b32 s32, 0, 0x80000000
    s_cmp_eq_u32 s34, 256
    s_cselect_b32 s33, s11, 0
    s_lshl_b32 s12, s33, 4
    s_sub_u32 s31, s31, s12
    s_and_b32 s12, s10, 1
    s_lshl_b32 s12, s12, 12
    s_add_u32 s31, s31, s12
    v_and_b32 v8, 1, v1
    v_mul_u32_u24 v148, 0x8000, v8
    v_mul_f32 v24, 0x3d000000, v3
    v_lshl_or_b32 v148, v148, 16, v148
    v_mul_f32 v20, v11, v24
    v_add_f32 v21, v20, v24
    v_add_f32 v22, v21, v24
    v_add_f32 v23, v22, v24
    v_cos_f32 v28, v20
    v_sin_f32 v29, v20
    v_cos_f32 v30, v21
    v_sin_f32 v31, v21
    v_cos_f32 v32, v22
    v_sin_f32 v33, v22
    v_cos_f32 v34, v23
    v_sin_f32 v35, v23
    v_cvt_pk_bf16_f32 v116, v28, v29
    v_cvt_pk_bf16_f32 v120, -v29, v28
    v_cvt_pk_bf16_f32 v117, v30, v31
    v_cvt_pk_bf16_f32 v121, -v31, v30
    v_cvt_pk_bf16_f32 v118, v32, v33
    v_cvt_pk_bf16_f32 v122, -v33, v32
    v_cvt_pk_bf16_f32 v119, v34, v35
    v_cvt_pk_bf16_f32 v123, -v35, v34
    v_xor_b32 v124, v148, v116
    v_xor_b32 v125, v148, v117
    v_xor_b32 v126, v148, v118
    v_xor_b32 v127, v148, v119
    v_xor_b32 v128, v148, v120
    v_xor_b32 v129, v148, v121
    v_xor_b32 v130, v148, v122
    v_xor_b32 v131, v148, v123
    v_mov_b32 v132, v116
    v_xor_b32 v133, 0x80008000, v117
    v_mov_b32 v134, v118
    v_xor_b32 v135, 0x80008000, v119
    v_mov_b32 v136, v120
    v_xor_b32 v137, 0x80008000, v121
    v_mov_b32 v138, v122
    v_xor_b32 v139, 0x80008000, v123
    v_mov_b32 v140, v124
    v_xor_b32 v141, 0x80008000, v125
    v_mov_b32 v142, v126
    v_xor_b32 v143, 0x80008000, v127
    v_mov_b32 v144, v128
    v_xor_b32 v145, 0x80008000, v129
    v_mov_b32 v146, v130
    v_xor_b32 v147, 0x80008000, v131
    v_lshrrev_b32 v8, 1, v2
    v_lshlrev_b32 v149, 12, v8
    v_and_b32 v8, 1, v2
    v_lshlrev_b32 v9, 8, v8
    v_add_u32 v149, v149, v9
    v_lshl_add_u32 v149, v1, 4, v149
    s_lshr_b32 s11, s10, 1
    s_lshl_b32 s11, s11, 10
    s_and_b32 s12, s10, 1
    s_lshl_b32 s12, s12, 9
    s_add_u32 s11, s11, s12
    v_add_u32 v149, s11, v149
    s_lshl_b32 s11, s10, 11
    v_add_u32 v150, s11, v15
    s_barrier
    ds_read_b128 v[152:155], v12 offset:0
    ds_read_b128 v[156:159], v12 offset:1024
    ds_read_b128 v[160:163], v12 offset:2048
    ds_read_b128 v[168:171], v12 offset:3072
    ds_read_b128 v[164:167], v12 offset:4096
    ds_read_b128 v[172:175], v12 offset:5120
    ds_read_b128 v[176:179], v12 offset:6144
    ds_read_b128 v[184:187], v12 offset:7168
    ds_read_b128 v[180:183], v12 offset:8192
    ds_read_b128 v[188:191], v12 offset:9216
    s_waitcnt vmcnt(0) lgkmcnt(0)
    v_mfma_f32_16x16x32_bf16 v[216:219], v[68:71], v[36:39], 0
    v_lshlrev_b32 v192, 16, v100
    v_and_b32 v196, 0xffff0000, v100
    v_mfma_f32_16x16x32_bf16 v[220:223], v[68:71], v[40:43], 0
    v_lshlrev_b32 v200, 16, v104
    v_and_b32 v204, 0xffff0000, v104
    v_mfma_f32_16x16x32_bf16 v[224:227], v[72:75], v[36:39], 0
    v_lshlrev_b32 v193, 16, v101
    v_and_b32 v197, 0xffff0000, v101
    v_mfma_f32_16x16x32_bf16 v[228:231], v[72:75], v[40:43], 0
    v_lshlrev_b32 v201, 16, v105
    v_and_b32 v205, 0xffff0000, v105
    v_mfma_f32_16x16x32_bf16 v[216:219], v[84:87], v[52:55], v[216:219]
    v_lshlrev_b32 v194, 16, v102
    v_and_b32 v198, 0xffff0000, v102
    v_mfma_f32_16x16x32_bf16 v[220:223], v[84:87], v[56:59], v[220:223]
    v_lshlrev_b32 v202, 16, v106
    v_and_b32 v206, 0xffff0000, v106
    v_mfma_f32_16x16x32_bf16 v[224:227], v[88:91], v[52:55], v[224:227]
    v_lshlrev_b32 v195, 16, v103
    v_and_b32 v199, 0xffff0000, v103
    v_mfma_f32_16x16x32_bf16 v[228:231], v[88:91], v[56:59], v[228:231]
    v_lshlrev_b32 v203, 16, v107
    v_and_b32 v207, 0xffff0000, v107
    v_mfma_f32_16x16x32_bf16 v[216:219], v[76:79], v[44:47], v[216:219]
    v_pk_add_f32 v[100:101], v[192:193], v[200:201]
    v_pk_add_f32 v[104:105], v[196:197], v[204:205]
    v_mfma_f32_16x16x32_bf16 v[220:223], v[76:79], v[48:51], v[220:223]
    v_pk_add_f32 v[192:193], v[192:193], v[200:201] neg_lo:[0,1] neg_hi:[0,1]
    v_pk_add_f32 v[196:197], v[196:197], v[204:205] neg_lo:[0,1] neg_hi:[0,1]
    v_mfma_f32_16x16x32_bf16 v[224:227], v[80:83], v[44:47], v[224:227]
    v_pk_add_f32 v[102:103], v[194:195], v[202:203]
    v_pk_add_f32 v[106:107], v[198:199], v[206:207]
    v_mfma_f32_16x16x32_bf16 v[228:231], v[80:83], v[48:51], v[228:231]
    v_pk_add_f32 v[194:195], v[194:195], v[202:203] neg_lo:[0,1] neg_hi:[0,1]
    v_pk_add_f32 v[198:199], v[198:199], v[206:207] neg_lo:[0,1] neg_hi:[0,1]
    v_mfma_f32_16x16x32_bf16 v[216:219], v[92:95], v[60:63], v[216:219]
    v_pk_fma_f32 v[100:101], v[192:193], v[156:157], v[100:101]
    v_pk_fma_f32 v[104:105], v[196:197], v[156:157], v[104:105]
    v_mfma_f32_16x16x32_bf16 v[220:223], v[92:95], v[64:67], v[220:223]
    v_pk_mul_f32 v[200:201], v[192:193], v[152:153]
    v_pk_mul_f32 v[204:205], v[196:197], v[152:153]
    v_mfma_f32_16x16x32_bf16 v[224:227], v[96:99], v[60:63], v[224:227]
    v_pk_fma_f32 v[102:103], v[194:195], v[158:159], v[102:103]
    v_pk_fma_f32 v[106:107], v[198:199], v[158:159], v[106:107]
    v_mfma_f32_16x16x32_bf16 v[228:231], v[96:99], v[64:67], v[228:231]
    v_pk_mul_f32 v[202:203], v[194:195], v[154:155]
    v_pk_mul_f32 v[206:207], v[198:199], v[154:155]
    v_lshlrev_b32 v192, 16, v108
    v_and_b32 v196, 0xffff0000, v108
    v_lshlrev_b32 v208, 16, v112
    v_and_b32 v212, 0xffff0000, v112
    v_lshlrev_b32 v193, 16, v109
    v_and_b32 v197, 0xffff0000, v109
    v_pk_mul_f32 v[84:85], v[216:217], v[160:161]
    v_pk_mul_f32 v[88:89], v[220:221], v[160:161]
    v_pk_fma_f32 v[84:85], v[220:221], v[168:169], v[84:85]
    v_pk_fma_f32 v[88:89], v[216:217], v[168:169], v[88:89] neg_lo:[1,0,0] neg_hi:[1,0,0]
    v_pk_mul_f32 v[86:87], v[218:219], v[162:163]
    v_pk_mul_f32 v[90:91], v[222:223], v[162:163]
    v_pk_fma_f32 v[86:87], v[222:223], v[170:171], v[86:87]
    v_pk_fma_f32 v[90:91], v[218:219], v[170:171], v[90:91] neg_lo:[1,0,0] neg_hi:[1,0,0]
    v_cvt_pk_bf16_f32 v28, v84, v88
    v_cvt_pk_bf16_f32 v29, v85, v89
    v_cvt_pk_bf16_f32 v30, v86, v90
    v_cvt_pk_bf16_f32 v31, v87, v91
    v_pk_mul_f32 v[92:93], v[224:225], v[164:165]
    v_pk_mul_f32 v[96:97], v[228:229], v[164:165]
    v_pk_fma_f32 v[92:93], v[228:229], v[172:173], v[92:93]
    v_pk_fma_f32 v[96:97], v[224:225], v[172:173], v[96:97] neg_lo:[1,0,0] neg_hi:[1,0,0]
    v_pk_mul_f32 v[94:95], v[226:227], v[166:167]
    v_pk_mul_f32 v[98:99], v[230:231], v[166:167]
    v_pk_fma_f32 v[94:95], v[230:231], v[174:175], v[94:95]
    v_pk_fma_f32 v[98:99], v[226:227], v[174:175], v[98:99] neg_lo:[1,0,0] neg_hi:[1,0,0]
    v_cvt_pk_bf16_f32 v32, v92, v96
    v_cvt_pk_bf16_f32 v33, v93, v97
    v_cvt_pk_bf16_f32 v34, v94, v98
    v_cvt_pk_bf16_f32 v35, v95, v99
    v_mfma_f32_16x16x32_bf16 v[216:219], v[116:119], v[28:31], 0
    v_lshlrev_b32 v209, 16, v113
    v_and_b32 v213, 0xffff0000, v113
    v_mfma_f32_16x16x32_bf16 v[220:223], v[120:123], v[28:31], 0
    v_lshlrev_b32 v194, 16, v110
    v_and_b32 v198, 0xffff0000, v110
    v_mfma_f32_16x16x32_bf16 v[224:227], v[132:135], v[28:31], 0
    v_lshlrev_b32 v210, 16, v114
    v_and_b32 v214, 0xffff0000, v114
    v_mfma_f32_16x16x32_bf16 v[228:231], v[136:139], v[28:31], 0
    v_lshlrev_b32 v195, 16, v111
    v_and_b32 v199, 0xffff0000, v111
    v_mfma_f32_16x16x32_bf16 v[216:219], v[124:127], v[32:35], v[216:219]
    v_lshlrev_b32 v211, 16, v115
    v_and_b32 v215, 0xffff0000, v115
    v_mfma_f32_16x16x32_bf16 v[220:223], v[128:131], v[32:35], v[220:223]
    v_pk_add_f32 v[108:109], v[192:193], v[208:209]
    v_pk_add_f32 v[112:113], v[196:197], v[212:213]
    v_mfma_f32_16x16x32_bf16 v[224:227], v[140:143], v[32:35], v[224:227]
    v_pk_add_f32 v[192:193], v[192:193], v[208:209] neg_lo:[0,1] neg_hi:[0,1]
    v_pk_add_f32 v[196:197], v[196:197], v[212:213] neg_lo:[0,1] neg_hi:[0,1]
    v_mfma_f32_16x16x32_bf16 v[228:231], v[144:147], v[32:35], v[228:231]
    v_pk_add_f32 v[110:111], v[194:195], v[210:211]
    v_pk_add_f32 v[114:115], v[198:199], v[214:215]
    v_pk_add_f32 v[194:195], v[194:195], v[210:211] neg_lo:[0,1] neg_hi:[0,1]
    v_pk_add_f32 v[198:199], v[198:199], v[214:215] neg_lo:[0,1] neg_hi:[0,1]
    v_pk_fma_f32 v[108:109], v[192:193], v[152:153], v[108:109] neg_lo:[0,1,0] neg_hi:[0,1,0]
    v_pk_fma_f32 v[112:113], v[196:197], v[152:153], v[112:113] neg_lo:[0,1,0] neg_hi:[0,1,0]
    v_pk_mul_f32 v[208:209], v[192:193], v[156:157]
    v_pk_mul_f32 v[212:213], v[196:197], v[156:157]
    v_pk_fma_f32 v[110:111], v[194:195], v[154:155], v[110:111] neg_lo:[0,1,0] neg_hi:[0,1,0]
    v_pk_fma_f32 v[114:115], v[198:199], v[154:155], v[114:115] neg_lo:[0,1,0] neg_hi:[0,1,0]
    v_pk_mul_f32 v[210:211], v[194:195], v[158:159]
    v_pk_mul_f32 v[214:215], v[198:199], v[158:159]
    v_mov_b32_dpp v84, v216 row_ror:8 row_mask:0xf bank_mask:0xf
    v_mov_b32_dpp v85, v217 row_ror:8 row_mask:0xf bank_mask:0xf
    v_mov_b32_dpp v86, v218 row_ror:8 row_mask:0xf bank_mask:0xf
    v_mov_b32_dpp v87, v219 row_ror:8 row_mask:0xf bank_mask:0xf
    v_mov_b32_dpp v88, v220 row_ror:8 row_mask:0xf bank_mask:0xf
    v_mov_b32_dpp v89, v221 row_ror:8 row_mask:0xf bank_mask:0xf
    v_mov_b32_dpp v90, v222 row_ror:8 row_mask:0xf bank_mask:0xf
    v_mov_b32_dpp v91, v223 row_ror:8 row_mask:0xf bank_mask:0xf
    v_pk_mul_f32 v[68:69], v[100:101], v[216:217]
    v_pk_mul_f32 v[70:71], v[102:103], v[218:219]
    v_pk_mul_f32 v[72:73], v[100:101], v[220:221]
    v_pk_mul_f32 v[74:75], v[102:103], v[222:223]
    v_pk_fma_f32 v[68:69], v[104:105], v[220:221], v[68:69] neg_lo:[1,0,0] neg_hi:[1,0,0]
    v_pk_fma_f32 v[70:71], v[106:107], v[222:223], v[70:71] neg_lo:[1,0,0] neg_hi:[1,0,0]
    v_pk_fma_f32 v[72:73], v[104:105], v[216:217], v[72:73]
    v_pk_fma_f32 v[74:75], v[106:107], v[218:219], v[74:75]
    v_pk_fma_f32 v[68:69], v[200:201], v[88:89], v[68:69] neg_lo:[1,0,0] neg_hi:[1,0,0]
    v_pk_fma_f32 v[70:71], v[202:203], v[90:91], v[70:71] neg_lo:[1,0,0] neg_hi:[1,0,0]
    v_pk_fma_f32 v[72:73], v[200:201], v[84:85], v[72:73]
    v_pk_fma_f32 v[74:75], v[202:203], v[86:87], v[74:75]
    v_pk_fma_f32 v[68:69], v[204:205], v[84:85], v[68:69] neg_lo:[1,0,0] neg_hi:[1,0,0]
    v_pk_fma_f32 v[70:71], v[206:207], v[86:87], v[70:71] neg_lo:[1,0,0] neg_hi:[1,0,0]
    v_pk_fma_f32 v[72:73], v[204:205], v[88:89], v[72:73] neg_lo:[1,0,0] neg_hi:[1,0,0]
    v_pk_fma_f32 v[74:75], v[206:207], v[90:91], v[74:75] neg_lo:[1,0,0] neg_hi:[1,0,0]
    v_cvt_pk_bf16_f32 v28, v68, -v72
    v_cvt_pk_bf16_f32 v29, v69, -v73
    v_cvt_pk_bf16_f32 v30, v70, -v74
    v_cvt_pk_bf16_f32 v31, v71, -v75
    v_mov_b32_dpp v92, v224 row_ror:8 row_mask:0xf bank_mask:0xf
    v_mov_b32_dpp v93, v225 row_ror:8 row_mask:0xf bank_mask:0xf
    v_mov_b32_dpp v94, v226 row_ror:8 row_mask:0xf bank_mask:0xf
    v_mov_b32_dpp v95, v227 row_ror:8 row_mask:0xf bank_mask:0xf
    v_mov_b32_dpp v96, v228 row_ror:8 row_mask:0xf bank_mask:0xf
    v_mov_b32_dpp v97, v229 row_ror:8 row_mask:0xf bank_mask:0xf
    v_mov_b32_dpp v98, v230 row_ror:8 row_mask:0xf bank_mask:0xf
    v_mov_b32_dpp v99, v231 row_ror:8 row_mask:0xf bank_mask:0xf
    v_pk_mul_f32 v[76:77], v[108:109], v[224:225]
    v_pk_mul_f32 v[78:79], v[110:111], v[226:227]
    v_pk_mul_f32 v[80:81], v[108:109], v[228:229]
    v_pk_mul_f32 v[82:83], v[110:111], v[230:231]
    v_pk_fma_f32 v[76:77], v[112:113], v[228:229], v[76:77] neg_lo:[1,0,0] neg_hi:[1,0,0]
    v_pk_fma_f32 v[78:79], v[114:115], v[230:231], v[78:79] neg_lo:[1,0,0] neg_hi:[1,0,0]
    v_pk_fma_f32 v[80:81], v[112:113], v[224:225], v[80:81]
    v_pk_fma_f32 v[82:83], v[114:115], v[226:227], v[82:83]
    v_pk_fma_f32 v[76:77], v[208:209], v[96:97], v[76:77] neg_lo:[1,0,0] neg_hi:[1,0,0]
    v_pk_fma_f32 v[78:79], v[210:211], v[98:99], v[78:79] neg_lo:[1,0,0] neg_hi:[1,0,0]
    v_pk_fma_f32 v[80:81], v[208:209], v[92:93], v[80:81]
    v_pk_fma_f32 v[82:83], v[210:211], v[94:95], v[82:83]
    v_pk_fma_f32 v[76:77], v[212:213], v[92:93], v[76:77] neg_lo:[1,0,0] neg_hi:[1,0,0]
    v_pk_fma_f32 v[78:79], v[214:215], v[94:95], v[78:79] neg_lo:[1,0,0] neg_hi:[1,0,0]
    v_pk_fma_f32 v[80:81], v[212:213], v[96:97], v[80:81] neg_lo:[1,0,0] neg_hi:[1,0,0]
    v_pk_fma_f32 v[82:83], v[214:215], v[98:99], v[82:83] neg_lo:[1,0,0] neg_hi:[1,0,0]
    v_cvt_pk_bf16_f32 v32, v76, -v80
    v_cvt_pk_bf16_f32 v33, v77, -v81
    v_cvt_pk_bf16_f32 v34, v78, -v82
    v_cvt_pk_bf16_f32 v35, v79, -v83
    v_mfma_f32_16x16x32_bf16 v[216:219], v[28:31], v[116:119], 0
    v_mfma_f32_16x16x32_bf16 v[220:223], v[28:31], v[120:123], 0
    v_mfma_f32_16x16x32_bf16 v[224:227], v[28:31], v[132:135], 0
    v_mfma_f32_16x16x32_bf16 v[228:231], v[28:31], v[136:139], 0
    v_mfma_f32_16x16x32_bf16 v[216:219], v[32:35], v[124:127], v[216:219]
    v_mfma_f32_16x16x32_bf16 v[220:223], v[32:35], v[128:131], v[220:223]
    v_mfma_f32_16x16x32_bf16 v[224:227], v[32:35], v[140:143], v[224:227]
    v_mfma_f32_16x16x32_bf16 v[228:231], v[32:35], v[144:147], v[228:231]
    s_nop 4
    v_pk_mul_f32 v[84:85], v[216:217], v[176:177]
    v_pk_mul_f32 v[88:89], v[220:221], v[176:177]
    v_pk_fma_f32 v[84:85], v[220:221], v[184:185], v[84:85]
    v_pk_fma_f32 v[88:89], v[216:217], v[184:185], v[88:89] neg_lo:[1,0,0] neg_hi:[1,0,0]
    v_pk_mul_f32 v[86:87], v[218:219], v[178:179]
    v_pk_mul_f32 v[90:91], v[222:223], v[178:179]
    v_pk_fma_f32 v[86:87], v[222:223], v[186:187], v[86:87]
    v_pk_fma_f32 v[90:91], v[218:219], v[186:187], v[90:91] neg_lo:[1,0,0] neg_hi:[1,0,0]
    v_cvt_pk_bf16_f32 v28, v84, v88
    v_cvt_pk_bf16_f32 v29, v85, v89
    v_cvt_pk_bf16_f32 v30, v86, v90
    v_cvt_pk_bf16_f32 v31, v87, v91
    v_pk_mul_f32 v[92:93], v[224:225], v[180:181]
    v_pk_mul_f32 v[96:97], v[228:229], v[180:181]
    v_pk_fma_f32 v[92:93], v[228:229], v[188:189], v[92:93]
    v_pk_fma_f32 v[96:97], v[224:225], v[188:189], v[96:97] neg_lo:[1,0,0] neg_hi:[1,0,0]
    v_pk_mul_f32 v[94:95], v[226:227], v[182:183]
    v_pk_mul_f32 v[98:99], v[230:231], v[182:183]
    v_pk_fma_f32 v[94:95], v[230:231], v[190:191], v[94:95]
    v_pk_fma_f32 v[98:99], v[226:227], v[190:191], v[98:99] neg_lo:[1,0,0] neg_hi:[1,0,0]
    v_cvt_pk_bf16_f32 v32, v92, v96
    v_cvt_pk_bf16_f32 v33, v93, v97
    v_cvt_pk_bf16_f32 v34, v94, v98
    v_cvt_pk_bf16_f32 v35, v95, v99
    ds_write_b128 v149, v[28:31] offset:0
    ds_write_b128 v149, v[32:35] offset:2048
    s_waitcnt lgkmcnt(0)
    s_barrier
    ds_read_b128 v[28:31], v150 offset:0
    ds_read_b128 v[32:35], v150 offset:1024
    s_waitcnt lgkmcnt(1)
    v_mfma_f32_16x16x32_bf16 v[216:219], v[28:31], v[116:119], 0
    v_mfma_f32_16x16x32_bf16 v[220:223], v[28:31], v[120:123], 0
    v_mfma_f32_16x16x32_bf16 v[224:227], v[28:31], v[132:135], 0
    v_mfma_f32_16x16x32_bf16 v[228:231], v[28:31], v[136:139], 0
    s_waitcnt lgkmcnt(0)
    v_mfma_f32_16x16x32_bf16 v[216:219], v[32:35], v[124:127], v[216:219]
    v_mfma_f32_16x16x32_bf16 v[220:223], v[32:35], v[128:131], v[220:223]
    v_mfma_f32_16x16x32_bf16 v[224:227], v[32:35], v[140:143], v[224:227]
    v_mfma_f32_16x16x32_bf16 v[228:231], v[32:35], v[144:147], v[228:231]
    s_cmp_lg_u32 s33, 0
    s_cbranch_scc1 B_zero
    s_nop 3
    v_cvt_pk_bf16_f32 v84, v216, v220
    v_cvt_pk_bf16_f32 v85, v217, v221
    v_cvt_pk_bf16_f32 v86, v218, v222
    v_cvt_pk_bf16_f32 v87, v219, v223
    v_xor_b32 v84, s32, v84
    v_xor_b32 v85, s32, v85
    v_xor_b32 v86, s32, v86
    v_xor_b32 v87, s32, v87
    buffer_store_dwordx4 v[84:87], v13, s[24:27], s31 offen offset:0
    v_cvt_pk_bf16_f32 v92, v224, v228
    v_cvt_pk_bf16_f32 v93, v225, v229
    v_cvt_pk_bf16_f32 v94, v226, v230
    v_cvt_pk_bf16_f32 v95, v227, v231
    v_xor_b32 v92, s32, v92
    v_xor_b32 v93, s32, v93
    v_xor_b32 v94, s32, v94
    v_xor_b32 v95, s32, v95
    buffer_store_dwordx4 v[92:95], v13, s[24:27], s31 offen offset:2048
    s_branch B_end
B_zero:
    v_mov_b32 v84, 0
    v_mov_b32 v85, 0
    v_mov_b32 v86, 0
    v_mov_b32 v87, 0
    buffer_store_dwordx4 v[84:87], v13, s[24:27], s31 offen offset:0
    buffer_store_dwordx4 v[84:87], v13, s[24:27], s31 offen offset:2048
B_end:
    s_branch B_done
B_helper:
    v_mul_f32 v23, 0x43000000, v4
    v_add_f32 v23, v23, v7
    v_mul_f32 v14, 0x3a000000, v23
    v_add_f32 v15, 0x3c800000, v14
    v_add_f32 v16, 0x3c800000, v15
    v_add_f32 v17, 0x3c800000, v16
    v_cos_f32 v28, v14
    v_sin_f32 v32, v14
    v_cos_f32 v29, v15
    v_sin_f32 v33, v15
    v_cos_f32 v30, v16
    v_sin_f32 v34, v16
    v_cos_f32 v31, v17
    v_sin_f32 v35, v17
    v_mov_b32 v68, v10
    v_mov_b32 v69, v10
    v_mul_f32 v22, 0x3a800000, v7
    v_mul_f32 v14, v11, v22
    v_mul_f32 v23, 0x41800000, v22
    v_add_f32 v18, v14, v23
    v_pk_mul_f32 v[32:33], v[32:33], v[68:69] neg_lo:[0,1] neg_hi:[0,1]
    v_pk_mul_f32 v[28:29], v[28:29], v[68:69]
    v_pk_mul_f32 v[34:35], v[34:35], v[68:69] neg_lo:[0,1] neg_hi:[0,1]
    v_pk_mul_f32 v[30:31], v[30:31], v[68:69]
    v_add_f32 v15, v14, v22
    v_add_f32 v19, v18, v22
    v_add_f32 v16, v15, v22
    v_add_f32 v20, v19, v22
    v_add_f32 v17, v16, v22
    v_add_f32 v21, v20, v22
    ds_write_b128 v12, v[28:31] offset:0
    ds_write_b128 v12, v[32:35] offset:1024
    v_cos_f32 v36, v14
    v_sin_f32 v40, v14
    v_cos_f32 v37, v15
    v_sin_f32 v41, v15
    v_cos_f32 v38, v16
    v_sin_f32 v42, v16
    v_cos_f32 v39, v17
    v_sin_f32 v43, v17
    v_cos_f32 v44, v18
    v_sin_f32 v48, v18
    v_cos_f32 v45, v19
    v_sin_f32 v49, v19
    v_cos_f32 v46, v20
    v_sin_f32 v50, v20
    v_cos_f32 v47, v21
    v_sin_f32 v51, v21
    ds_write_b128 v12, v[36:39] offset:2048
    ds_write_b128 v12, v[40:43] offset:3072
    ds_write_b128 v12, v[44:47] offset:4096
    ds_write_b128 v12, v[48:51] offset:5120
    v_and_b32 v8, 1, v2
    v_lshlrev_b32 v8, 2, v8
    s_lshl_b32 s11, s13, 3
    v_add_u32 v8, s11, v8
    v_cvt_f32_u32 v24, v8
    v_mul_f32 v22, 0x3a800000, v3
    v_add_f32 v23, 0x3c800000, v22
    v_mul_f32 v14, v24, v22
    v_mul_f32 v18, v24, v23
    v_add_f32 v15, v14, v22
    v_add_f32 v19, v18, v23
    v_add_f32 v16, v15, v22
    v_add_f32 v20, v19, v23
    v_add_f32 v17, v16, v22
    v_add_f32 v21, v20, v23
    v_cos_f32 v52, v14
    v_sin_f32 v56, v14
    v_cos_f32 v53, v15
    v_sin_f32 v57, v15
    v_cos_f32 v54, v16
    v_sin_f32 v58, v16
    v_cos_f32 v55, v17
    v_sin_f32 v59, v17
    v_cos_f32 v60, v18
    v_sin_f32 v64, v18
    v_cos_f32 v61, v19
    v_sin_f32 v65, v19
    v_cos_f32 v62, v20
    v_sin_f32 v66, v20
    v_cos_f32 v63, v21
    v_sin_f32 v67, v21
    s_mov_b32 s16, 0x35800000
    s_mov_b32 s17, 0x35800000
    v_pk_mul_f32 v[52:53], v[52:53], s[16:17]
    v_pk_mul_f32 v[54:55], v[54:55], s[16:17]
    v_pk_mul_f32 v[56:57], v[56:57], s[16:17]
    v_pk_mul_f32 v[58:59], v[58:59], s[16:17]
    v_pk_mul_f32 v[60:61], v[60:61], s[16:17]
    v_pk_mul_f32 v[62:63], v[62:63], s[16:17]
    v_pk_mul_f32 v[64:65], v[64:65], s[16:17]
    v_pk_mul_f32 v[66:67], v[66:67], s[16:17]
    ds_write_b128 v12, v[52:55] offset:6144
    ds_write_b128 v12, v[56:59] offset:7168
    ds_write_b128 v12, v[60:63] offset:8192
    ds_write_b128 v12, v[64:67] offset:9216
    s_waitcnt lgkmcnt(0)
    s_barrier
    s_mov_b32 s20, s6
    s_mov_b32 s21, s7
    s_and_b32 s21, s21, 0xffff
    s_mov_b32 s22, 0x1c0000
    s_mov_b32 s23, 0x20000
    s_mul_i32 s24, s2, 7168
    s_mul_i32 s25, s13, 1792
    s_add_u32 s24, s24, s25
    v_min_u32 v70, 13, v5
    v_lshlrev_b32 v70, 7, v70
    buffer_load_dword v72, v70, s[20:23], s24 offen
    s_mov_b32 s20, s8
    s_mov_b32 s21, s9
    s_and_b32 s21, s21, 0xffff
    s_mov_b32 s22, 0x1c0000
    s_mov_b32 s23, 0x20000
    s_mul_i32 s26, s2, 7168
    s_mul_i32 s27, s13, 1792
    s_add_u32 s26, s26, s27
    v_min_u32 v70, 13, v5
    v_lshlrev_b32 v70, 7, v70
    buffer_load_dword v73, v70, s[20:23], s26 offen
    s_add_u32 s28, s4, 0x1200000
    s_addc_u32 s29, s5, 0
    s_and_b32 s29, s29, 0xffff
    s_mov_b32 s30, 0x10000
    s_mov_b32 s31, 0x20000
    s_lshl_b32 s11, s2, 8
    s_lshl_b32 s12, s13, 6
    s_add_u32 s11, s11, s12
    v_lshlrev_b32 v8, 4, v5
    v_mov_b32 v28, 0
    v_mov_b32 v29, 0
    v_mov_b32 v30, 0
    v_mov_b32 v31, 0
    s_mov_b64 s[32:33], exec
    s_mov_b64 exec, 0xf
    buffer_store_dwordx4 v[28:31], v8, s[28:31], s11 offen
    s_mov_b64 exec, s[32:33]
    s_barrier
B_done:
    s_endpgm

.text
.globl sequential_preLN__spectral_gfnet__glu_gated_reglu__prompt_kernel
.p2align 8
.type sequential_preLN__spectral_gfnet__glu_gated_reglu__prompt_kernel,@function
sequential_preLN__spectral_gfnet__glu_gated_reglu__prompt_kernel:
    s_cmp_ge_u32 s2, 256
    s_cbranch_scc1 F_done
    s_load_dwordx2 s[4:5], s[0:1], 0
    s_load_dwordx2 s[6:7], s[0:1], 72
    s_load_dwordx2 s[8:9], s[0:1], 32
    s_load_dwordx2 s[10:11], s[0:1], 40
    s_load_dwordx2 s[12:13], s[0:1], 48
    s_load_dwordx2 s[14:15], s[0:1], 56
    v_lshrrev_b32 v2, 6, v0
    s_nop 0
    v_readfirstlane_b32 s16, v2
    v_and_b32 v3, 63, v0
    v_and_b32 v1, 15, v0
    v_lshrrev_b32 v2, 4, v3
    s_and_b32 s17, s2, 1
    s_lshl_b32 s19, s17, 3
    s_bfe_u32 s17, s2, 0x30003
    s_add_u32 s19, s19, s17
    s_bfe_u32 s17, s2, 0x20001
    s_lshl_b32 s20, s17, 2
    s_lshr_b32 s17, s2, 6
    s_add_u32 s20, s20, s17
    s_lshl_b32 s21, s19, 1
    s_lshr_b32 s17, s20, 3
    s_add_u32 s21, s21, s17
    s_and_b32 s22, s20, 7
    s_lshl_b32 s26, s19, 4
    s_lshr_b32 s17, s20, 2
    s_add_u32 s26, s26, s17
    s_and_b32 s17, s20, 3
    s_lshl_b32 s17, s17, 2
    s_add_u32 s26, s26, s17
    s_cmp_ge_u32 s16, 4
    s_cbranch_scc1 F_loader
    s_bfe_u32 s17, s26, 0x10002
    s_lshl_b32 s44, s17, 7
    s_lshr_b32 s17, s26, 7
    s_lshl_b32 s17, s17, 6
    s_add_u32 s44, s44, s17
    s_and_b32 s17, s26, 3
    s_lshl_b32 s17, s17, 4
    s_add_u32 s44, s44, s17
    s_bfe_u32 s17, s26, 0x40003
    s_add_u32 s44, s44, s17
    s_lshl_b32 s44, s44, 5
    s_add_u32 s45, s44, 1048576
    s_lshl_b32 s47, s26, 13
    s_lshl_b32 s17, s16, 11
    s_add_u32 s46, s47, s17
    v_lshrrev_b32 v8, 1, v0
    v_lshlrev_b32 v8, 13, v8
    v_and_b32 v4, 1, v0
    v_lshl_add_u32 v8, v4, 4, v8
    v_lshlrev_b32 v9, 5, v1
    v_lshl_add_u32 v9, v2, 3, v9
    s_waitcnt lgkmcnt(0)
    s_add_u32 s32, s6, 0x800000
    s_addc_u32 s33, s7, 0
    s_and_b32 s33, s33, 0xffff
    s_mov_b32 s34, 0x200000
    s_mov_b32 s35, 0x20000
    buffer_load_dwordx4 v[12:15], v8, s[32:35], s44 offen
    buffer_load_dwordx4 v[16:19], v8, s[32:35], s45 offen
    s_mov_b32 s28, s4
    s_mov_b32 s29, s5
    s_and_b32 s29, s29, 0xffff
    s_mov_b32 s30, 0x200000
    s_mov_b32 s31, 0x20000
    buffer_load_dwordx2 v[20:21], v9, s[28:31], s46 offen offset:0
    buffer_load_dwordx2 v[24:25], v9, s[28:31], s46 offen offset:1024
    buffer_load_dwordx2 v[22:23], v9, s[28:31], s46 offen offset:512
    buffer_load_dwordx2 v[26:27], v9, s[28:31], s46 offen offset:1536
    s_add_u32 s36, s6, 0xa00000
    s_addc_u32 s37, s7, 0
    s_and_b32 s37, s37, 0xffff
    s_mov_b32 s38, 0x200000
    s_mov_b32 s39, 0x20000
    s_add_u32 s40, s6, 0xc00000
    s_addc_u32 s41, s7, 0
    s_and_b32 s41, s41, 0xffff
    s_mov_b32 s42, 0x200000
    s_mov_b32 s43, 0x20000
    s_add_u32 s24, s6, 0x1200000
    s_addc_u32 s25, s7, 0
    v_cvt_f32_u32 v6, v1
    v_cvt_f32_u32 v7, v2
    v_mul_f32 v29, 0x3d800000, v6
    v_mul_f32 v28, v6, v7
    v_mul_f32 v28, 0x3e800000, v28
    v_cos_f32 v30, v28
    v_sin_f32 v31, v28
    v_add_f32 v28, v28, v29
    v_cvt_pk_bf16_f32 v36, v30, v31
    v_cvt_pk_bf16_f32 v40, -v31, v30
    v_cos_f32 v30, v28
    v_sin_f32 v31, v28
    v_add_f32 v28, v28, v29
    v_cvt_pk_bf16_f32 v37, v30, v31
    v_cvt_pk_bf16_f32 v41, -v31, v30
    v_cos_f32 v30, v28
    v_sin_f32 v31, v28
    v_add_f32 v28, v28, v29
    v_cvt_pk_bf16_f32 v38, v30, v31
    v_cvt_pk_bf16_f32 v42, -v31, v30
    v_cos_f32 v30, v28
    v_sin_f32 v31, v28
    s_nop 0
    v_cvt_pk_bf16_f32 v39, v30, v31
    v_cvt_pk_bf16_f32 v43, -v31, v30
    v_mul_f32 v29, 0x3b000000, v6
    v_mul_f32 v32, 4.0, v7
    v_mul_f32 v44, v32, v29
    v_mul_f32 v32, 0x41800000, v29
    v_add_f32 v48, v44, v32
    v_add_f32 v45, v44, v29
    v_add_f32 v49, v48, v29
    v_add_f32 v46, v45, v29
    v_add_f32 v50, v49, v29
    v_add_f32 v47, v46, v29
    v_add_f32 v51, v50, v29
    v_cos_f32 v52, v44
    v_sin_f32 v60, v44
    v_cos_f32 v53, v45
    v_sin_f32 v61, v45
    v_cos_f32 v54, v46
    v_sin_f32 v62, v46
    v_cos_f32 v55, v47
    v_sin_f32 v63, v47
    v_cos_f32 v56, v48
    v_sin_f32 v64, v48
    v_cos_f32 v57, v49
    v_sin_f32 v65, v49
    v_cos_f32 v58, v50
    v_sin_f32 v66, v50
    v_cos_f32 v59, v51
    v_sin_f32 v67, v51
    v_and_b32 v4, 1, v1
    v_mul_u32_u24 v4, 0x8000, v4
    v_lshl_or_b32 v4, v4, 16, v4
    v_mul_f32 v29, 0x3d000000, v6
    v_mul_f32 v28, 4.0, v7
    v_mul_f32 v28, v28, v29
    v_cos_f32 v30, v28
    v_sin_f32 v31, v28
    v_add_f32 v28, v28, v29
    v_cvt_pk_bf16_f32 v68, v30, v31
    v_cvt_pk_bf16_f32 v72, -v31, v30
    v_cos_f32 v30, v28
    v_sin_f32 v31, v28
    v_add_f32 v28, v28, v29
    v_cvt_pk_bf16_f32 v69, v30, v31
    v_cvt_pk_bf16_f32 v73, -v31, v30
    v_cos_f32 v30, v28
    v_sin_f32 v31, v28
    v_add_f32 v28, v28, v29
    v_cvt_pk_bf16_f32 v70, v30, v31
    v_cvt_pk_bf16_f32 v74, -v31, v30
    v_cos_f32 v30, v28
    v_sin_f32 v31, v28
    s_nop 0
    v_cvt_pk_bf16_f32 v71, v30, v31
    v_cvt_pk_bf16_f32 v75, -v31, v30
    v_xor_b32 v76, v4, v68
    v_xor_b32 v77, v4, v69
    v_xor_b32 v78, v4, v70
    v_xor_b32 v79, v4, v71
    v_xor_b32 v80, v4, v72
    v_xor_b32 v81, v4, v73
    v_xor_b32 v82, v4, v74
    v_xor_b32 v83, v4, v75
    v_mov_b32 v84, v68
    v_xor_b32 v85, 0x80008000, v69
    v_mov_b32 v86, v70
    v_xor_b32 v87, 0x80008000, v71
    v_mov_b32 v88, v72
    v_xor_b32 v89, 0x80008000, v73
    v_mov_b32 v90, v74
    v_xor_b32 v91, 0x80008000, v75
    v_mov_b32 v92, v76
    v_xor_b32 v93, 0x80008000, v77
    v_mov_b32 v94, v78
    v_xor_b32 v95, 0x80008000, v79
    v_mov_b32 v96, v80
    v_xor_b32 v97, 0x80008000, v81
    v_mov_b32 v98, v82
    v_xor_b32 v99, 0x80008000, v83
    v_lshrrev_b32 v4, 1, v0
    v_sub_u32 v5, 512, v4
    v_cmp_eq_u32 vcc, 0, v4
    v_mov_b32 v100, 256
    s_nop 0
    v_cndmask_b32 v5, v5, v100, vcc
    v_and_b32 v100, 1, v0
    v_cmp_eq_u32 vcc, 1, v100
    s_nop 1
    v_cndmask_b32 v4, v4, v5, vcc
    v_lshrrev_b32 v5, 7, v4
    v_lshl_add_u32 v100, v5, 4, v4
    v_lshlrev_b32 v100, 2, v100
    v_add_u32 v100, 135168, v100
    v_lshrrev_b32 v4, 1, v0
    v_add_u32 v4, 128, v4
    v_sub_u32 v5, 512, v4
    v_and_b32 v101, 1, v0
    v_cmp_eq_u32 vcc, 1, v101
    s_nop 1
    v_cndmask_b32 v4, v4, v5, vcc
    v_lshrrev_b32 v5, 7, v4
    v_lshl_add_u32 v101, v5, 4, v4
    v_lshlrev_b32 v101, 2, v101
    v_add_u32 v101, 135168, v101
    v_mul_u32_u24 v102, 144, v2
    v_add_u32 v102, v102, v1
    s_mul_i32 s17, s16, 576
    s_add_u32 s17, s17, 33792
    v_add_u32 v102, s17, v102
    v_lshlrev_b32 v102, 2, v102
    v_lshrrev_b32 v103, 3, v0
    v_lshlrev_b32 v103, 8, v103
    v_and_b32 v4, 7, v0
    v_lshl_add_u32 v103, v4, 4, v103
    s_lshr_b32 s17, s26, 1
    s_lshl_b32 s48, s17, 14
    s_and_b32 s17, s26, 1
    s_lshl_b32 s17, s17, 7
    s_add_u32 s48, s48, s17
    v_lshl_add_u32 v4, v1, 2, v2
    v_lshlrev_b32 v4, 7, v4
    v_and_b32 v5, 7, v1
    s_lshl_b32 s17, s16, 1
    v_xor_b32 v104, s17, v5
    v_lshl_add_u32 v104, v104, 4, v4
    v_add_u32 v104, 144384, v104
    v_xor_b32 v105, 16, v104
    v_bfe_u32 v5, v0, 5, 3
    v_and_b32 v4, 7, v0
    v_xor_b32 v5, v5, v4
    v_lshrrev_b32 v4, 3, v0
    v_lshlrev_b32 v4, 7, v4
    v_lshl_add_u32 v106, v5, 4, v4
    v_add_u32 v106, 144384, v106
    v_add_u32 v107, 4096, v106
    s_mul_i32 s17, s16, 2304
    s_add_u32 s17, s17, 135168
    v_add_u32 v108, s17, v9
    v_lshrrev_b32 v4, 7, v0
    v_mul_u32_u24 v109, 2304, v4
    v_bfe_u32 v4, v0, 6, 1
    v_lshl_add_u32 v109, v4, 10, v109
    v_lshl_add_u32 v109, v3, 4, v109
    v_add_u32 v109, 135168, v109
    v_lshlrev_b32 v110, 4, v0
    s_waitcnt vmcnt(5)
    ds_write_b32 v100, v12 offset:0
    ds_write_b32 v100, v13 offset:2304
    ds_write_b32 v100, v14 offset:4608
    ds_write_b32 v100, v15 offset:6912
    s_waitcnt vmcnt(4)
    ds_write_b32 v101, v16 offset:0
    ds_write_b32 v101, v17 offset:2304
    ds_write_b32 v101, v18 offset:4608
    ds_write_b32 v101, v19 offset:6912
    s_waitcnt lgkmcnt(0)
    s_barrier
    ds_read2_b32 v[112:113], v102 offset0:0 offset1:32
    ds_read2_b32 v[114:115], v102 offset0:64 offset1:96
    ds_read2_b32 v[116:117], v102 offset0:16 offset1:48
    ds_read2_b32 v[118:119], v102 offset0:80 offset1:112
    s_waitcnt lgkmcnt(2)
    v_mfma_f32_16x16x32_bf16 v[120:123], v[112:115], v[36:39], 0
    v_mfma_f32_16x16x32_bf16 v[124:127], v[112:115], v[40:43], 0
    s_waitcnt lgkmcnt(0)
    v_mfma_f32_16x16x32_bf16 v[128:131], v[116:119], v[36:39], 0
    v_mfma_f32_16x16x32_bf16 v[132:135], v[116:119], v[40:43], 0
    s_waitcnt vmcnt(0)
    v_lshlrev_b32 v136, 16, v20
    v_lshlrev_b32 v137, 16, v24
    v_and_b32 v138, 0xffff0000, v20
    v_and_b32 v139, 0xffff0000, v24
    v_lshlrev_b32 v140, 16, v21
    v_lshlrev_b32 v141, 16, v25
    v_and_b32 v142, 0xffff0000, v21
    v_and_b32 v143, 0xffff0000, v25
    v_lshlrev_b32 v144, 16, v22
    v_lshlrev_b32 v145, 16, v26
    v_and_b32 v146, 0xffff0000, v22
    v_and_b32 v147, 0xffff0000, v26
    v_lshlrev_b32 v148, 16, v23
    v_lshlrev_b32 v149, 16, v27
    v_and_b32 v150, 0xffff0000, v23
    v_and_b32 v151, 0xffff0000, v27
    v_pk_mul_f32 v[152:153], v[120:121], v[52:53]
    v_pk_mul_f32 v[156:157], v[124:125], v[52:53]
    v_pk_fma_f32 v[152:153], v[124:125], v[60:61], v[152:153]
    v_pk_fma_f32 v[156:157], v[120:121], v[60:61], v[156:157] neg_lo:[1,0,0] neg_hi:[1,0,0]
    v_pk_mul_f32 v[154:155], v[122:123], v[54:55]
    v_pk_mul_f32 v[158:159], v[126:127], v[54:55]
    v_pk_fma_f32 v[154:155], v[126:127], v[62:63], v[154:155]
    v_pk_fma_f32 v[158:159], v[122:123], v[62:63], v[158:159] neg_lo:[1,0,0] neg_hi:[1,0,0]
    v_cvt_pk_bf16_f32 v112, v152, v156
    v_cvt_pk_bf16_f32 v113, v153, v157
    v_cvt_pk_bf16_f32 v114, v154, v158
    v_cvt_pk_bf16_f32 v115, v155, v159
    v_pk_mul_f32 v[160:161], v[128:129], v[56:57]
    v_pk_mul_f32 v[164:165], v[132:133], v[56:57]
    v_pk_fma_f32 v[160:161], v[132:133], v[64:65], v[160:161]
    v_pk_fma_f32 v[164:165], v[128:129], v[64:65], v[164:165] neg_lo:[1,0,0] neg_hi:[1,0,0]
    v_pk_mul_f32 v[162:163], v[130:131], v[58:59]
    v_pk_mul_f32 v[166:167], v[134:135], v[58:59]
    v_pk_fma_f32 v[162:163], v[134:135], v[66:67], v[162:163]
    v_pk_fma_f32 v[166:167], v[130:131], v[66:67], v[166:167] neg_lo:[1,0,0] neg_hi:[1,0,0]
    v_cvt_pk_bf16_f32 v116, v160, v164
    v_cvt_pk_bf16_f32 v117, v161, v165
    v_cvt_pk_bf16_f32 v118, v162, v166
    v_cvt_pk_bf16_f32 v119, v163, v167
    v_mfma_f32_16x16x32_bf16 v[120:123], v[112:115], v[68:71], 0
    v_mfma_f32_16x16x32_bf16 v[124:127], v[112:115], v[72:75], 0
    v_mfma_f32_16x16x32_bf16 v[128:131], v[112:115], v[84:87], 0
    v_mfma_f32_16x16x32_bf16 v[132:135], v[112:115], v[88:91], 0
    v_mfma_f32_16x16x32_bf16 v[120:123], v[116:119], v[76:79], v[120:123]
    v_mfma_f32_16x16x32_bf16 v[124:127], v[116:119], v[80:83], v[124:127]
    v_mfma_f32_16x16x32_bf16 v[128:131], v[116:119], v[92:95], v[128:131]
    v_mfma_f32_16x16x32_bf16 v[132:135], v[116:119], v[96:99], v[132:135]
    s_nop 4
    v_add_f32 v136, v136, v120
    v_sub_f32 v137, v137, v124
    v_add_f32 v138, v138, v121
    v_sub_f32 v139, v139, v125
    v_add_f32 v140, v140, v122
    v_sub_f32 v141, v141, v126
    v_add_f32 v142, v142, v123
    v_sub_f32 v143, v143, v127
    v_add_f32 v144, v144, v128
    v_sub_f32 v145, v145, v132
    v_add_f32 v146, v146, v129
    v_sub_f32 v147, v147, v133
    v_add_f32 v148, v148, v130
    v_sub_f32 v149, v149, v134
    v_add_f32 v150, v150, v131
    v_sub_f32 v151, v151, v135
    v_cvt_pk_bf16_f32 v20, v136, v138
    v_cvt_pk_bf16_f32 v24, v137, v139
    v_cvt_pk_bf16_f32 v21, v140, v142
    v_cvt_pk_bf16_f32 v25, v141, v143
    v_cvt_pk_bf16_f32 v22, v144, v146
    v_cvt_pk_bf16_f32 v26, v145, v147
    v_cvt_pk_bf16_f32 v23, v148, v150
    v_cvt_pk_bf16_f32 v27, v149, v151
    ds_write_b64 v108, v[20:21] offset:0
    ds_write_b64 v108, v[24:25] offset:1024
    ds_write_b64 v108, v[22:23] offset:512
    ds_write_b64 v108, v[26:27] offset:1536
    v_readfirstlane_b32 s50, v136
    v_readfirstlane_b32 s51, v137
    s_nop 1
    v_pk_add_f32 v[136:137], v[136:137], s[50:51] neg_lo:[0,1] neg_hi:[0,1]
    v_pk_add_f32 v[138:139], v[138:139], s[50:51] neg_lo:[0,1] neg_hi:[0,1]
    v_pk_add_f32 v[140:141], v[140:141], s[50:51] neg_lo:[0,1] neg_hi:[0,1]
    v_pk_add_f32 v[142:143], v[142:143], s[50:51] neg_lo:[0,1] neg_hi:[0,1]
    v_pk_add_f32 v[144:145], v[144:145], s[50:51] neg_lo:[0,1] neg_hi:[0,1]
    v_pk_add_f32 v[146:147], v[146:147], s[50:51] neg_lo:[0,1] neg_hi:[0,1]
    v_pk_add_f32 v[148:149], v[148:149], s[50:51] neg_lo:[0,1] neg_hi:[0,1]
    v_pk_add_f32 v[150:151], v[150:151], s[50:51] neg_lo:[0,1] neg_hi:[0,1]
    v_pk_add_f32 v[168:169], v[136:137], v[138:139]
    v_pk_mul_f32 v[170:171], v[136:137], v[136:137]
    v_pk_add_f32 v[172:173], v[140:141], v[142:143]
    v_pk_mul_f32 v[174:175], v[138:139], v[138:139]
    v_pk_add_f32 v[168:169], v[168:169], v[144:145]
    v_pk_fma_f32 v[170:171], v[140:141], v[140:141], v[170:171]
    v_pk_add_f32 v[172:173], v[172:173], v[146:147]
    v_pk_fma_f32 v[174:175], v[142:143], v[142:143], v[174:175]
    v_pk_add_f32 v[168:169], v[168:169], v[148:149]
    v_pk_fma_f32 v[170:171], v[144:145], v[144:145], v[170:171]
    v_pk_add_f32 v[172:173], v[172:173], v[150:151]
    v_pk_fma_f32 v[174:175], v[146:147], v[146:147], v[174:175]
    v_pk_fma_f32 v[170:171], v[148:149], v[148:149], v[170:171]
    v_pk_add_f32 v[168:169], v[168:169], v[172:173]
    v_pk_fma_f32 v[174:175], v[150:151], v[150:151], v[174:175]
    v_pk_add_f32 v[170:171], v[170:171], v[174:175]
    v_add_f32_dpp v168, v168, v168 row_ror:8 row_mask:0xf bank_mask:0xf
    v_add_f32_dpp v169, v169, v169 row_ror:8 row_mask:0xf bank_mask:0xf
    v_add_f32_dpp v170, v170, v170 row_ror:8 row_mask:0xf bank_mask:0xf
    v_add_f32_dpp v171, v171, v171 row_ror:8 row_mask:0xf bank_mask:0xf
    v_add_f32_dpp v168, v168, v168 row_ror:4 row_mask:0xf bank_mask:0xf
    v_add_f32_dpp v169, v169, v169 row_ror:4 row_mask:0xf bank_mask:0xf
    v_add_f32_dpp v170, v170, v170 row_ror:4 row_mask:0xf bank_mask:0xf
    v_add_f32_dpp v171, v171, v171 row_ror:4 row_mask:0xf bank_mask:0xf
    v_add_f32_dpp v168, v168, v168 row_ror:2 row_mask:0xf bank_mask:0xf
    v_add_f32_dpp v169, v169, v169 row_ror:2 row_mask:0xf bank_mask:0xf
    v_add_f32_dpp v170, v170, v170 row_ror:2 row_mask:0xf bank_mask:0xf
    v_add_f32_dpp v171, v171, v171 row_ror:2 row_mask:0xf bank_mask:0xf
    v_add_f32_dpp v168, v168, v168 row_ror:1 row_mask:0xf bank_mask:0xf
    v_add_f32_dpp v169, v169, v169 row_ror:1 row_mask:0xf bank_mask:0xf
    v_add_f32_dpp v170, v170, v170 row_ror:1 row_mask:0xf bank_mask:0xf
    v_add_f32_dpp v171, v171, v171 row_ror:1 row_mask:0xf bank_mask:0xf
    v_add_f32_dpp v168, v168, v168 row_bcast:15 row_mask:0xa bank_mask:0xf
    v_add_f32_dpp v169, v169, v169 row_bcast:15 row_mask:0xa bank_mask:0xf
    v_add_f32_dpp v170, v170, v170 row_bcast:15 row_mask:0xa bank_mask:0xf
    v_add_f32_dpp v171, v171, v171 row_bcast:15 row_mask:0xa bank_mask:0xf
    v_add_f32_dpp v168, v168, v168 row_bcast:31 row_mask:0xc bank_mask:0xf
    v_add_f32_dpp v169, v169, v169 row_bcast:31 row_mask:0xc bank_mask:0xf
    v_add_f32_dpp v170, v170, v170 row_bcast:31 row_mask:0xc bank_mask:0xf
    v_add_f32_dpp v171, v171, v171 row_bcast:31 row_mask:0xc bank_mask:0xf
    v_mov_b32 v4, 0x3727c5ac
    v_mov_b32 v5, 0x3b000000
    v_mul_f32 v168, v5, v168
    v_mul_f32 v169, v5, v169
    v_fma_f32 v170, v170, v5, v4
    v_fma_f32 v171, v171, v5, v4
    v_fma_f32 v170, -v168, v168, v170
    v_fma_f32 v171, -v169, v169, v171
    v_max_f32 v170, v4, v170
    v_max_f32 v171, v4, v171
    v_rsq_f32 v170, v170
    v_rsq_f32 v171, v171
    v_mul_f32 v168, v168, v170
    v_mul_f32 v169, v169, v171
    v_readlane_b32 s52, v170, 63
    v_readlane_b32 s53, v171, 63
    v_readlane_b32 s50, v168, 63
    v_readlane_b32 s51, v169, 63
    s_nop 0
    v_mov_b32 v172, s50
    v_mov_b32 v173, s51
    v_pk_fma_f32 v[136:137], v[136:137], s[52:53], v[172:173] neg_lo:[0,0,1] neg_hi:[0,0,1]
    v_pk_fma_f32 v[138:139], v[138:139], s[52:53], v[172:173] neg_lo:[0,0,1] neg_hi:[0,0,1]
    v_pk_fma_f32 v[140:141], v[140:141], s[52:53], v[172:173] neg_lo:[0,0,1] neg_hi:[0,0,1]
    v_pk_fma_f32 v[142:143], v[142:143], s[52:53], v[172:173] neg_lo:[0,0,1] neg_hi:[0,0,1]
    v_pk_fma_f32 v[144:145], v[144:145], s[52:53], v[172:173] neg_lo:[0,0,1] neg_hi:[0,0,1]
    v_pk_fma_f32 v[146:147], v[146:147], s[52:53], v[172:173] neg_lo:[0,0,1] neg_hi:[0,0,1]
    v_pk_fma_f32 v[148:149], v[148:149], s[52:53], v[172:173] neg_lo:[0,0,1] neg_hi:[0,0,1]
    v_pk_fma_f32 v[150:151], v[150:151], s[52:53], v[172:173] neg_lo:[0,0,1] neg_hi:[0,0,1]
    v_cvt_pk_bf16_f32 v12, v136, v138
    v_cvt_pk_bf16_f32 v16, v137, v139
    v_cvt_pk_bf16_f32 v13, v140, v142
    v_cvt_pk_bf16_f32 v17, v141, v143
    v_cvt_pk_bf16_f32 v14, v144, v146
    v_cvt_pk_bf16_f32 v18, v145, v147
    v_cvt_pk_bf16_f32 v15, v148, v150
    v_cvt_pk_bf16_f32 v19, v149, v151
    ds_write_b128 v104, v[12:15]
    ds_write_b128 v105, v[16:19]
    s_waitcnt lgkmcnt(0)
    s_barrier
    ds_read_b128 v[12:15], v106
    ds_read_b128 v[16:19], v107
    ds_read_b128 v[152:155], v109
    ds_read_b128 v[156:159], v109 offset:4608
    s_add_u32 s17, s48, 8192
    s_waitcnt lgkmcnt(2)
    buffer_store_dwordx4 v[12:15], v103, s[40:43], s48 offen sc1
    buffer_store_dwordx4 v[16:19], v103, s[40:43], s17 offen sc1
    s_waitcnt vmcnt(0) lgkmcnt(0)
    s_barrier
    s_cmp_eq_u32 s16, 0
    s_cbranch_scc1 F_h1skip
    s_add_u32 s17, s47, 4096
    buffer_store_dwordx4 v[152:155], v110, s[36:39], s47 offen sc1
    buffer_store_dwordx4 v[156:159], v110, s[36:39], s17 offen sc1
F_h1skip:
    s_cmp_lg_u32 s16, 0
    s_cbranch_scc1 F_w1
    s_mov_b64 s[54:55], exec
    s_mov_b64 exec, 0xffff
    s_lshr_b32 s17, s26, 4
    s_lshl_b32 s17, s17, 11
    s_and_b32 s18, s26, 15
    s_lshl_b32 s18, s18, 2
    s_add_u32 s17, s17, s18
    v_lshlrev_b32 v4, 7, v3
    v_add_u32 v4, s17, v4
    v_mov_b32 v5, 1
    global_store_dword v4, v5, s[24:25] sc1
    s_lshl_b32 s17, s19, 4
    s_add_u32 s17, s17, s20
    s_lshl_b32 s17, s17, 7
    v_lshlrev_b32 v4, 2, v3
    v_add_u32 v4, s17, v4
    s_mov_b32 s56, 0
F_p1_poll:
    global_load_dword v5, v4, s[24:25] sc1
    s_add_u32 s56, s56, 1
    s_waitcnt vmcnt(0)
    v_cmp_eq_u32 vcc, 0, v5
    s_cmp_gt_u32 s56, 100000
    s_cbranch_scc1 F_p1_out
    s_cbranch_vccz F_p1_out
    s_sleep 2
    s_branch F_p1_poll
F_p1_out:
    s_mov_b64 exec, s[54:55]
    s_add_u32 s17, s47, 4096
    buffer_store_dwordx4 v[152:155], v110, s[36:39], s47 offen sc1
    buffer_store_dwordx4 v[156:159], v110, s[36:39], s17 offen sc1
F_w1:
    s_barrier
    v_bfe_u32 v4, v3, 2, 2
    v_lshl_add_u32 v4, v2, 2, v4
    v_mul_u32_u24 v6, 224, v4
    v_and_b32 v4, 3, v3
    v_lshl_add_u32 v6, v4, 3, v6
    s_lshl_b32 s17, s16, 11
    s_add_u32 s17, s17, 14336
    v_lshlrev_b32 v12, 4, v3
    v_add_u32 v9, s17, v12
    s_lshl_b32 s17, s19, 3
    s_lshl_b32 s18, s16, 1
    s_add_u32 s17, s17, s18
    s_mul_i32 s32, s17, 57344
    s_mul_i32 s17, s20, 7
    s_lshr_b32 s17, s17, 1
    s_lshl_b32 s17, s17, 10
    s_add_u32 s32, s32, s17
    s_add_u32 s33, s32, 57344
    s_mov_b32 s28, s6
    s_mov_b32 s29, s7
    s_and_b32 s29, s29, 0xffff
    s_mov_b32 s30, 0x700000
    s_mov_b32 s31, 0x20000
    s_add_u32 s40, s6, 0x1300000
    s_addc_u32 s41, s7, 0
    s_and_b32 s41, s41, 0xffff
    s_mov_b32 s42, 0x100000
    s_mov_b32 s43, 0x20000
    s_lshl_b32 s17, s19, 2
    s_add_u32 s17, s17, s16
    s_lshl_b32 s44, s17, 14
    s_lshl_b32 s17, s20, 10
    s_add_u32 s44, s44, s17
    s_barrier
    v_add_u32 v7, 0, v6
    v_add_u32 v10, 0, v9
    ds_read_b128 a[36:39], v10 offset:0
    ds_read_b128 a[40:43], v10 offset:1024
    ds_read_b64_tr_b16 a[0:1], v7 offset:0
    ds_read_b64_tr_b16 a[2:3], v7 offset:3584
    ds_read_b64_tr_b16 a[4:5], v7 offset:7168
    ds_read_b64_tr_b16 a[6:7], v7 offset:10752
    ds_read_b64_tr_b16 a[8:9], v7 offset:32
    ds_read_b64_tr_b16 a[10:11], v7 offset:3616
    ds_read_b64_tr_b16 a[12:13], v7 offset:7200
    ds_read_b64_tr_b16 a[14:15], v7 offset:10784
    ds_read_b64_tr_b16 a[16:17], v7 offset:64
    ds_read_b64_tr_b16 a[18:19], v7 offset:3648
    ds_read_b64_tr_b16 a[20:21], v7 offset:7232
    ds_read_b64_tr_b16 a[22:23], v7 offset:10816
    ds_read_b64_tr_b16 a[24:25], v7 offset:96
    ds_read_b64_tr_b16 a[26:27], v7 offset:3680
    s_waitcnt lgkmcnt(10)
    v_mfma_f32_16x16x32_bf16 v[20:23], a[0:3], a[36:39], 0
    ds_read_b64_tr_b16 a[28:29], v7 offset:7264
    v_mfma_f32_16x16x32_bf16 v[24:27], a[0:3], a[40:43], 0
    ds_read_b64_tr_b16 a[30:31], v7 offset:10848
    v_mfma_f32_16x16x32_bf16 v[28:31], a[4:7], a[36:39], 0
    ds_read_b64_tr_b16 a[32:33], v7 offset:128
    v_mfma_f32_16x16x32_bf16 v[32:35], a[4:7], a[40:43], 0
    ds_read_b64_tr_b16 a[34:35], v7 offset:3712
    s_waitcnt lgkmcnt(10)
    v_mfma_f32_16x16x32_bf16 v[36:39], a[8:11], a[36:39], 0
    ds_read_b64_tr_b16 a[0:1], v7 offset:7296
    v_mfma_f32_16x16x32_bf16 v[40:43], a[8:11], a[40:43], 0
    ds_read_b64_tr_b16 a[2:3], v7 offset:10880
    v_mfma_f32_16x16x32_bf16 v[44:47], a[12:15], a[36:39], 0
    ds_read_b64_tr_b16 a[4:5], v7 offset:160
    v_mfma_f32_16x16x32_bf16 v[48:51], a[12:15], a[40:43], 0
    ds_read_b64_tr_b16 a[6:7], v7 offset:3744
    s_waitcnt lgkmcnt(10)
    v_mfma_f32_16x16x32_bf16 v[52:55], a[16:19], a[36:39], 0
    ds_read_b64_tr_b16 a[8:9], v7 offset:7328
    v_mfma_f32_16x16x32_bf16 v[56:59], a[16:19], a[40:43], 0
    ds_read_b64_tr_b16 a[10:11], v7 offset:10912
    v_mfma_f32_16x16x32_bf16 v[60:63], a[20:23], a[36:39], 0
    ds_read_b64_tr_b16 a[12:13], v7 offset:192
    v_mfma_f32_16x16x32_bf16 v[64:67], a[20:23], a[40:43], 0
    ds_read_b64_tr_b16 a[14:15], v7 offset:3776
    s_waitcnt lgkmcnt(10)
    v_mfma_f32_16x16x32_bf16 v[68:71], a[24:27], a[36:39], 0
    ds_read_b64_tr_b16 a[16:17], v7 offset:7360
    v_mfma_f32_16x16x32_bf16 v[72:75], a[24:27], a[40:43], 0
    ds_read_b64_tr_b16 a[18:19], v7 offset:10944
    s_barrier
    v_add_u32 v8, 22528, v6
    v_add_u32 v11, 22528, v9
    ds_read_b128 a[44:47], v11 offset:0
    ds_read_b128 a[48:51], v11 offset:1024
    v_mfma_f32_16x16x32_bf16 v[76:79], a[28:31], a[36:39], 0
    ds_read_b64_tr_b16 a[20:21], v8 offset:0
    v_mfma_f32_16x16x32_bf16 v[80:83], a[28:31], a[40:43], 0
    ds_read_b64_tr_b16 a[22:23], v8 offset:3584
    s_waitcnt lgkmcnt(12)
    v_mfma_f32_16x16x32_bf16 v[84:87], a[32:35], a[36:39], 0
    ds_read_b64_tr_b16 a[24:25], v8 offset:7168
    v_mfma_f32_16x16x32_bf16 v[88:91], a[32:35], a[40:43], 0
    ds_read_b64_tr_b16 a[26:27], v8 offset:10752
    v_mfma_f32_16x16x32_bf16 v[92:95], a[0:3], a[36:39], 0
    ds_read_b64_tr_b16 a[28:29], v8 offset:32
    v_mfma_f32_16x16x32_bf16 v[96:99], a[0:3], a[40:43], 0
    ds_read_b64_tr_b16 a[30:31], v8 offset:3616
    s_waitcnt lgkmcnt(12)
    v_mfma_f32_16x16x32_bf16 v[100:103], a[4:7], a[36:39], 0
    ds_read_b64_tr_b16 a[32:33], v8 offset:7200
    v_mfma_f32_16x16x32_bf16 v[104:107], a[4:7], a[40:43], 0
    ds_read_b64_tr_b16 a[34:35], v8 offset:10784
    v_mfma_f32_16x16x32_bf16 v[108:111], a[8:11], a[36:39], 0
    ds_read_b64_tr_b16 a[0:1], v8 offset:64
    v_mfma_f32_16x16x32_bf16 v[112:115], a[8:11], a[40:43], 0
    ds_read_b64_tr_b16 a[2:3], v8 offset:3648
    s_waitcnt lgkmcnt(12)
    v_mfma_f32_16x16x32_bf16 v[116:119], a[12:15], a[36:39], 0
    ds_read_b64_tr_b16 a[4:5], v8 offset:7232
    v_mfma_f32_16x16x32_bf16 v[120:123], a[12:15], a[40:43], 0
    ds_read_b64_tr_b16 a[6:7], v8 offset:10816
    v_mfma_f32_16x16x32_bf16 v[124:127], a[16:19], a[36:39], 0
    ds_read_b64_tr_b16 a[8:9], v8 offset:96
    v_mfma_f32_16x16x32_bf16 v[128:131], a[16:19], a[40:43], 0
    ds_read_b64_tr_b16 a[10:11], v8 offset:3680
    s_waitcnt lgkmcnt(10)
    v_mfma_f32_16x16x32_bf16 v[20:23], a[20:23], a[44:47], v[20:23]
    ds_read_b64_tr_b16 a[12:13], v8 offset:7264
    v_mfma_f32_16x16x32_bf16 v[24:27], a[20:23], a[48:51], v[24:27]
    ds_read_b64_tr_b16 a[14:15], v8 offset:10848
    v_mfma_f32_16x16x32_bf16 v[28:31], a[24:27], a[44:47], v[28:31]
    ds_read_b64_tr_b16 a[16:17], v8 offset:128
    v_mfma_f32_16x16x32_bf16 v[32:35], a[24:27], a[48:51], v[32:35]
    ds_read_b64_tr_b16 a[18:19], v8 offset:3712
    s_waitcnt lgkmcnt(10)
    v_mfma_f32_16x16x32_bf16 v[36:39], a[28:31], a[44:47], v[36:39]
    ds_read_b64_tr_b16 a[20:21], v8 offset:7296
    v_mfma_f32_16x16x32_bf16 v[40:43], a[28:31], a[48:51], v[40:43]
    ds_read_b64_tr_b16 a[22:23], v8 offset:10880
    v_mfma_f32_16x16x32_bf16 v[44:47], a[32:35], a[44:47], v[44:47]
    ds_read_b64_tr_b16 a[24:25], v8 offset:160
    v_mfma_f32_16x16x32_bf16 v[48:51], a[32:35], a[48:51], v[48:51]
    ds_read_b64_tr_b16 a[26:27], v8 offset:3744
    s_waitcnt lgkmcnt(10)
    v_mfma_f32_16x16x32_bf16 v[52:55], a[0:3], a[44:47], v[52:55]
    ds_read_b64_tr_b16 a[28:29], v8 offset:7328
    v_mfma_f32_16x16x32_bf16 v[56:59], a[0:3], a[48:51], v[56:59]
    ds_read_b64_tr_b16 a[30:31], v8 offset:10912
    v_mfma_f32_16x16x32_bf16 v[60:63], a[4:7], a[44:47], v[60:63]
    ds_read_b64_tr_b16 a[32:33], v8 offset:192
    v_mfma_f32_16x16x32_bf16 v[64:67], a[4:7], a[48:51], v[64:67]
    ds_read_b64_tr_b16 a[34:35], v8 offset:3776
    s_waitcnt lgkmcnt(10)
    v_mfma_f32_16x16x32_bf16 v[68:71], a[8:11], a[44:47], v[68:71]
    ds_read_b64_tr_b16 a[0:1], v8 offset:7360
    v_mfma_f32_16x16x32_bf16 v[72:75], a[8:11], a[48:51], v[72:75]
    ds_read_b64_tr_b16 a[2:3], v8 offset:10944
    s_barrier
    v_add_u32 v7, 45056, v6
    v_add_u32 v10, 45056, v9
    ds_read_b128 a[36:39], v10 offset:0
    ds_read_b128 a[40:43], v10 offset:1024
    v_mfma_f32_16x16x32_bf16 v[76:79], a[12:15], a[44:47], v[76:79]
    ds_read_b64_tr_b16 a[4:5], v7 offset:0
    v_mfma_f32_16x16x32_bf16 v[80:83], a[12:15], a[48:51], v[80:83]
    ds_read_b64_tr_b16 a[6:7], v7 offset:3584
    s_waitcnt lgkmcnt(12)
    v_mfma_f32_16x16x32_bf16 v[84:87], a[16:19], a[44:47], v[84:87]
    ds_read_b64_tr_b16 a[8:9], v7 offset:7168
    v_mfma_f32_16x16x32_bf16 v[88:91], a[16:19], a[48:51], v[88:91]
    ds_read_b64_tr_b16 a[10:11], v7 offset:10752
    v_mfma_f32_16x16x32_bf16 v[92:95], a[20:23], a[44:47], v[92:95]
    ds_read_b64_tr_b16 a[12:13], v7 offset:32
    v_mfma_f32_16x16x32_bf16 v[96:99], a[20:23], a[48:51], v[96:99]
    ds_read_b64_tr_b16 a[14:15], v7 offset:3616
    s_waitcnt lgkmcnt(12)
    v_mfma_f32_16x16x32_bf16 v[100:103], a[24:27], a[44:47], v[100:103]
    ds_read_b64_tr_b16 a[16:17], v7 offset:7200
    v_mfma_f32_16x16x32_bf16 v[104:107], a[24:27], a[48:51], v[104:107]
    ds_read_b64_tr_b16 a[18:19], v7 offset:10784
    v_mfma_f32_16x16x32_bf16 v[108:111], a[28:31], a[44:47], v[108:111]
    ds_read_b64_tr_b16 a[20:21], v7 offset:64
    v_mfma_f32_16x16x32_bf16 v[112:115], a[28:31], a[48:51], v[112:115]
    ds_read_b64_tr_b16 a[22:23], v7 offset:3648
    s_waitcnt lgkmcnt(12)
    v_mfma_f32_16x16x32_bf16 v[116:119], a[32:35], a[44:47], v[116:119]
    ds_read_b64_tr_b16 a[24:25], v7 offset:7232
    v_mfma_f32_16x16x32_bf16 v[120:123], a[32:35], a[48:51], v[120:123]
    ds_read_b64_tr_b16 a[26:27], v7 offset:10816
    v_mfma_f32_16x16x32_bf16 v[124:127], a[0:3], a[44:47], v[124:127]
    ds_read_b64_tr_b16 a[28:29], v7 offset:96
    v_mfma_f32_16x16x32_bf16 v[128:131], a[0:3], a[48:51], v[128:131]
    ds_read_b64_tr_b16 a[30:31], v7 offset:3680
    s_waitcnt lgkmcnt(10)
    v_mfma_f32_16x16x32_bf16 v[20:23], a[4:7], a[36:39], v[20:23]
    ds_read_b64_tr_b16 a[32:33], v7 offset:7264
    v_mfma_f32_16x16x32_bf16 v[24:27], a[4:7], a[40:43], v[24:27]
    ds_read_b64_tr_b16 a[34:35], v7 offset:10848
    v_mfma_f32_16x16x32_bf16 v[28:31], a[8:11], a[36:39], v[28:31]
    ds_read_b64_tr_b16 a[0:1], v7 offset:128
    v_mfma_f32_16x16x32_bf16 v[32:35], a[8:11], a[40:43], v[32:35]
    ds_read_b64_tr_b16 a[2:3], v7 offset:3712
    s_waitcnt lgkmcnt(10)
    v_mfma_f32_16x16x32_bf16 v[36:39], a[12:15], a[36:39], v[36:39]
    ds_read_b64_tr_b16 a[4:5], v7 offset:7296
    v_mfma_f32_16x16x32_bf16 v[40:43], a[12:15], a[40:43], v[40:43]
    ds_read_b64_tr_b16 a[6:7], v7 offset:10880
    v_mfma_f32_16x16x32_bf16 v[44:47], a[16:19], a[36:39], v[44:47]
    ds_read_b64_tr_b16 a[8:9], v7 offset:160
    v_mfma_f32_16x16x32_bf16 v[48:51], a[16:19], a[40:43], v[48:51]
    ds_read_b64_tr_b16 a[10:11], v7 offset:3744
    s_waitcnt lgkmcnt(10)
    v_mfma_f32_16x16x32_bf16 v[52:55], a[20:23], a[36:39], v[52:55]
    ds_read_b64_tr_b16 a[12:13], v7 offset:7328
    v_mfma_f32_16x16x32_bf16 v[56:59], a[20:23], a[40:43], v[56:59]
    ds_read_b64_tr_b16 a[14:15], v7 offset:10912
    v_mfma_f32_16x16x32_bf16 v[60:63], a[24:27], a[36:39], v[60:63]
    ds_read_b64_tr_b16 a[16:17], v7 offset:192
    v_mfma_f32_16x16x32_bf16 v[64:67], a[24:27], a[40:43], v[64:67]
    ds_read_b64_tr_b16 a[18:19], v7 offset:3776
    s_waitcnt lgkmcnt(10)
    v_mfma_f32_16x16x32_bf16 v[68:71], a[28:31], a[36:39], v[68:71]
    ds_read_b64_tr_b16 a[20:21], v7 offset:7360
    v_mfma_f32_16x16x32_bf16 v[72:75], a[28:31], a[40:43], v[72:75]
    ds_read_b64_tr_b16 a[22:23], v7 offset:10944
    v_add_u32 v8, 67584, v6
    v_add_u32 v11, 67584, v9
    ds_read_b128 a[44:47], v11 offset:0
    ds_read_b128 a[48:51], v11 offset:1024
    v_mfma_f32_16x16x32_bf16 v[76:79], a[32:35], a[36:39], v[76:79]
    ds_read_b64_tr_b16 a[24:25], v8 offset:0
    v_mfma_f32_16x16x32_bf16 v[80:83], a[32:35], a[40:43], v[80:83]
    ds_read_b64_tr_b16 a[26:27], v8 offset:3584
    s_waitcnt lgkmcnt(12)
    v_mfma_f32_16x16x32_bf16 v[84:87], a[0:3], a[36:39], v[84:87]
    ds_read_b64_tr_b16 a[28:29], v8 offset:7168
    v_mfma_f32_16x16x32_bf16 v[88:91], a[0:3], a[40:43], v[88:91]
    ds_read_b64_tr_b16 a[30:31], v8 offset:10752
    v_mfma_f32_16x16x32_bf16 v[92:95], a[4:7], a[36:39], v[92:95]
    ds_read_b64_tr_b16 a[32:33], v8 offset:32
    v_mfma_f32_16x16x32_bf16 v[96:99], a[4:7], a[40:43], v[96:99]
    ds_read_b64_tr_b16 a[34:35], v8 offset:3616
    s_waitcnt lgkmcnt(12)
    v_mfma_f32_16x16x32_bf16 v[100:103], a[8:11], a[36:39], v[100:103]
    ds_read_b64_tr_b16 a[0:1], v8 offset:7200
    v_mfma_f32_16x16x32_bf16 v[104:107], a[8:11], a[40:43], v[104:107]
    ds_read_b64_tr_b16 a[2:3], v8 offset:10784
    v_mfma_f32_16x16x32_bf16 v[108:111], a[12:15], a[36:39], v[108:111]
    ds_read_b64_tr_b16 a[4:5], v8 offset:64
    v_mfma_f32_16x16x32_bf16 v[112:115], a[12:15], a[40:43], v[112:115]
    ds_read_b64_tr_b16 a[6:7], v8 offset:3648
    s_waitcnt lgkmcnt(12)
    v_mfma_f32_16x16x32_bf16 v[116:119], a[16:19], a[36:39], v[116:119]
    ds_read_b64_tr_b16 a[8:9], v8 offset:7232
    v_mfma_f32_16x16x32_bf16 v[120:123], a[16:19], a[40:43], v[120:123]
    ds_read_b64_tr_b16 a[10:11], v8 offset:10816
    v_mfma_f32_16x16x32_bf16 v[124:127], a[20:23], a[36:39], v[124:127]
    ds_read_b64_tr_b16 a[12:13], v8 offset:96
    v_mfma_f32_16x16x32_bf16 v[128:131], a[20:23], a[40:43], v[128:131]
    ds_read_b64_tr_b16 a[14:15], v8 offset:3680
    s_waitcnt lgkmcnt(10)
    v_mfma_f32_16x16x32_bf16 v[20:23], a[24:27], a[44:47], v[20:23]
    ds_read_b64_tr_b16 a[16:17], v8 offset:7264
    v_mfma_f32_16x16x32_bf16 v[24:27], a[24:27], a[48:51], v[24:27]
    ds_read_b64_tr_b16 a[18:19], v8 offset:10848
    v_mfma_f32_16x16x32_bf16 v[28:31], a[28:31], a[44:47], v[28:31]
    ds_read_b64_tr_b16 a[20:21], v8 offset:128
    v_mfma_f32_16x16x32_bf16 v[32:35], a[28:31], a[48:51], v[32:35]
    ds_read_b64_tr_b16 a[22:23], v8 offset:3712
    s_waitcnt lgkmcnt(10)
    v_mfma_f32_16x16x32_bf16 v[36:39], a[32:35], a[44:47], v[36:39]
    ds_read_b64_tr_b16 a[24:25], v8 offset:7296
    v_mfma_f32_16x16x32_bf16 v[40:43], a[32:35], a[48:51], v[40:43]
    ds_read_b64_tr_b16 a[26:27], v8 offset:10880
    v_mfma_f32_16x16x32_bf16 v[44:47], a[0:3], a[44:47], v[44:47]
    ds_read_b64_tr_b16 a[28:29], v8 offset:160
    v_mfma_f32_16x16x32_bf16 v[48:51], a[0:3], a[48:51], v[48:51]
    ds_read_b64_tr_b16 a[30:31], v8 offset:3744
    s_waitcnt lgkmcnt(10)
    v_mfma_f32_16x16x32_bf16 v[52:55], a[4:7], a[44:47], v[52:55]
    ds_read_b64_tr_b16 a[32:33], v8 offset:7328
    v_mfma_f32_16x16x32_bf16 v[56:59], a[4:7], a[48:51], v[56:59]
    ds_read_b64_tr_b16 a[34:35], v8 offset:10912
    v_mfma_f32_16x16x32_bf16 v[60:63], a[8:11], a[44:47], v[60:63]
    ds_read_b64_tr_b16 a[0:1], v8 offset:192
    v_mfma_f32_16x16x32_bf16 v[64:67], a[8:11], a[48:51], v[64:67]
    ds_read_b64_tr_b16 a[2:3], v8 offset:3776
    s_waitcnt lgkmcnt(10)
    v_mfma_f32_16x16x32_bf16 v[68:71], a[12:15], a[44:47], v[68:71]
    ds_read_b64_tr_b16 a[4:5], v8 offset:7360
    v_mfma_f32_16x16x32_bf16 v[72:75], a[12:15], a[48:51], v[72:75]
    ds_read_b64_tr_b16 a[6:7], v8 offset:10944
    s_barrier
    v_add_u32 v7, 90112, v6
    v_add_u32 v10, 90112, v9
    ds_read_b128 a[36:39], v10 offset:0
    ds_read_b128 a[40:43], v10 offset:1024
    v_mfma_f32_16x16x32_bf16 v[76:79], a[16:19], a[44:47], v[76:79]
    ds_read_b64_tr_b16 a[8:9], v7 offset:0
    v_mfma_f32_16x16x32_bf16 v[80:83], a[16:19], a[48:51], v[80:83]
    ds_read_b64_tr_b16 a[10:11], v7 offset:3584
    s_waitcnt lgkmcnt(12)
    v_mfma_f32_16x16x32_bf16 v[84:87], a[20:23], a[44:47], v[84:87]
    ds_read_b64_tr_b16 a[12:13], v7 offset:7168
    v_mfma_f32_16x16x32_bf16 v[88:91], a[20:23], a[48:51], v[88:91]
    ds_read_b64_tr_b16 a[14:15], v7 offset:10752
    v_mfma_f32_16x16x32_bf16 v[92:95], a[24:27], a[44:47], v[92:95]
    ds_read_b64_tr_b16 a[16:17], v7 offset:32
    v_mfma_f32_16x16x32_bf16 v[96:99], a[24:27], a[48:51], v[96:99]
    ds_read_b64_tr_b16 a[18:19], v7 offset:3616
    s_waitcnt lgkmcnt(12)
    v_mfma_f32_16x16x32_bf16 v[100:103], a[28:31], a[44:47], v[100:103]
    ds_read_b64_tr_b16 a[20:21], v7 offset:7200
    v_mfma_f32_16x16x32_bf16 v[104:107], a[28:31], a[48:51], v[104:107]
    ds_read_b64_tr_b16 a[22:23], v7 offset:10784
    v_mfma_f32_16x16x32_bf16 v[108:111], a[32:35], a[44:47], v[108:111]
    ds_read_b64_tr_b16 a[24:25], v7 offset:64
    v_mfma_f32_16x16x32_bf16 v[112:115], a[32:35], a[48:51], v[112:115]
    ds_read_b64_tr_b16 a[26:27], v7 offset:3648
    s_waitcnt lgkmcnt(12)
    v_mfma_f32_16x16x32_bf16 v[116:119], a[0:3], a[44:47], v[116:119]
    ds_read_b64_tr_b16 a[28:29], v7 offset:7232
    v_mfma_f32_16x16x32_bf16 v[120:123], a[0:3], a[48:51], v[120:123]
    ds_read_b64_tr_b16 a[30:31], v7 offset:10816
    v_mfma_f32_16x16x32_bf16 v[124:127], a[4:7], a[44:47], v[124:127]
    ds_read_b64_tr_b16 a[32:33], v7 offset:96
    v_mfma_f32_16x16x32_bf16 v[128:131], a[4:7], a[48:51], v[128:131]
    ds_read_b64_tr_b16 a[34:35], v7 offset:3680
    s_waitcnt lgkmcnt(10)
    v_mfma_f32_16x16x32_bf16 v[20:23], a[8:11], a[36:39], v[20:23]
    ds_read_b64_tr_b16 a[0:1], v7 offset:7264
    v_mfma_f32_16x16x32_bf16 v[24:27], a[8:11], a[40:43], v[24:27]
    ds_read_b64_tr_b16 a[2:3], v7 offset:10848
    v_mfma_f32_16x16x32_bf16 v[28:31], a[12:15], a[36:39], v[28:31]
    ds_read_b64_tr_b16 a[4:5], v7 offset:128
    v_mfma_f32_16x16x32_bf16 v[32:35], a[12:15], a[40:43], v[32:35]
    ds_read_b64_tr_b16 a[6:7], v7 offset:3712
    s_waitcnt lgkmcnt(10)
    v_mfma_f32_16x16x32_bf16 v[36:39], a[16:19], a[36:39], v[36:39]
    ds_read_b64_tr_b16 a[8:9], v7 offset:7296
    v_mfma_f32_16x16x32_bf16 v[40:43], a[16:19], a[40:43], v[40:43]
    ds_read_b64_tr_b16 a[10:11], v7 offset:10880
    v_mfma_f32_16x16x32_bf16 v[44:47], a[20:23], a[36:39], v[44:47]
    ds_read_b64_tr_b16 a[12:13], v7 offset:160
    v_mfma_f32_16x16x32_bf16 v[48:51], a[20:23], a[40:43], v[48:51]
    ds_read_b64_tr_b16 a[14:15], v7 offset:3744
    s_waitcnt lgkmcnt(10)
    v_mfma_f32_16x16x32_bf16 v[52:55], a[24:27], a[36:39], v[52:55]
    ds_read_b64_tr_b16 a[16:17], v7 offset:7328
    v_mfma_f32_16x16x32_bf16 v[56:59], a[24:27], a[40:43], v[56:59]
    ds_read_b64_tr_b16 a[18:19], v7 offset:10912
    v_mfma_f32_16x16x32_bf16 v[60:63], a[28:31], a[36:39], v[60:63]
    ds_read_b64_tr_b16 a[20:21], v7 offset:192
    v_mfma_f32_16x16x32_bf16 v[64:67], a[28:31], a[40:43], v[64:67]
    ds_read_b64_tr_b16 a[22:23], v7 offset:3776
    s_waitcnt lgkmcnt(10)
    v_mfma_f32_16x16x32_bf16 v[68:71], a[32:35], a[36:39], v[68:71]
    ds_read_b64_tr_b16 a[24:25], v7 offset:7360
    v_mfma_f32_16x16x32_bf16 v[72:75], a[32:35], a[40:43], v[72:75]
    ds_read_b64_tr_b16 a[26:27], v7 offset:10944
    v_add_u32 v8, 112640, v6
    v_add_u32 v11, 112640, v9
    ds_read_b128 a[44:47], v11 offset:0
    ds_read_b128 a[48:51], v11 offset:1024
    v_mfma_f32_16x16x32_bf16 v[76:79], a[0:3], a[36:39], v[76:79]
    ds_read_b64_tr_b16 a[28:29], v8 offset:0
    v_mfma_f32_16x16x32_bf16 v[80:83], a[0:3], a[40:43], v[80:83]
    ds_read_b64_tr_b16 a[30:31], v8 offset:3584
    s_waitcnt lgkmcnt(12)
    v_mfma_f32_16x16x32_bf16 v[84:87], a[4:7], a[36:39], v[84:87]
    ds_read_b64_tr_b16 a[32:33], v8 offset:7168
    v_mfma_f32_16x16x32_bf16 v[88:91], a[4:7], a[40:43], v[88:91]
    ds_read_b64_tr_b16 a[34:35], v8 offset:10752
    v_mfma_f32_16x16x32_bf16 v[92:95], a[8:11], a[36:39], v[92:95]
    ds_read_b64_tr_b16 a[0:1], v8 offset:32
    v_mfma_f32_16x16x32_bf16 v[96:99], a[8:11], a[40:43], v[96:99]
    ds_read_b64_tr_b16 a[2:3], v8 offset:3616
    s_waitcnt lgkmcnt(12)
    v_mfma_f32_16x16x32_bf16 v[100:103], a[12:15], a[36:39], v[100:103]
    ds_read_b64_tr_b16 a[4:5], v8 offset:7200
    v_mfma_f32_16x16x32_bf16 v[104:107], a[12:15], a[40:43], v[104:107]
    ds_read_b64_tr_b16 a[6:7], v8 offset:10784
    v_mfma_f32_16x16x32_bf16 v[108:111], a[16:19], a[36:39], v[108:111]
    ds_read_b64_tr_b16 a[8:9], v8 offset:64
    v_mfma_f32_16x16x32_bf16 v[112:115], a[16:19], a[40:43], v[112:115]
    ds_read_b64_tr_b16 a[10:11], v8 offset:3648
    s_waitcnt lgkmcnt(12)
    v_mfma_f32_16x16x32_bf16 v[116:119], a[20:23], a[36:39], v[116:119]
    ds_read_b64_tr_b16 a[12:13], v8 offset:7232
    v_mfma_f32_16x16x32_bf16 v[120:123], a[20:23], a[40:43], v[120:123]
    ds_read_b64_tr_b16 a[14:15], v8 offset:10816
    v_mfma_f32_16x16x32_bf16 v[124:127], a[24:27], a[36:39], v[124:127]
    ds_read_b64_tr_b16 a[16:17], v8 offset:96
    v_mfma_f32_16x16x32_bf16 v[128:131], a[24:27], a[40:43], v[128:131]
    ds_read_b64_tr_b16 a[18:19], v8 offset:3680
    s_waitcnt lgkmcnt(10)
    v_mfma_f32_16x16x32_bf16 v[20:23], a[28:31], a[44:47], v[20:23]
    ds_read_b64_tr_b16 a[20:21], v8 offset:7264
    v_mfma_f32_16x16x32_bf16 v[24:27], a[28:31], a[48:51], v[24:27]
    ds_read_b64_tr_b16 a[22:23], v8 offset:10848
    v_mfma_f32_16x16x32_bf16 v[28:31], a[32:35], a[44:47], v[28:31]
    ds_read_b64_tr_b16 a[24:25], v8 offset:128
    v_mfma_f32_16x16x32_bf16 v[32:35], a[32:35], a[48:51], v[32:35]
    ds_read_b64_tr_b16 a[26:27], v8 offset:3712
    s_waitcnt lgkmcnt(10)
    v_mfma_f32_16x16x32_bf16 v[36:39], a[0:3], a[44:47], v[36:39]
    ds_read_b64_tr_b16 a[28:29], v8 offset:7296
    v_mfma_f32_16x16x32_bf16 v[40:43], a[0:3], a[48:51], v[40:43]
    ds_read_b64_tr_b16 a[30:31], v8 offset:10880
    v_mfma_f32_16x16x32_bf16 v[44:47], a[4:7], a[44:47], v[44:47]
    ds_read_b64_tr_b16 a[32:33], v8 offset:160
    v_mfma_f32_16x16x32_bf16 v[48:51], a[4:7], a[48:51], v[48:51]
    ds_read_b64_tr_b16 a[34:35], v8 offset:3744
    s_waitcnt lgkmcnt(10)
    v_mfma_f32_16x16x32_bf16 v[52:55], a[8:11], a[44:47], v[52:55]
    ds_read_b64_tr_b16 a[0:1], v8 offset:7328
    v_mfma_f32_16x16x32_bf16 v[56:59], a[8:11], a[48:51], v[56:59]
    ds_read_b64_tr_b16 a[2:3], v8 offset:10912
    v_mfma_f32_16x16x32_bf16 v[60:63], a[12:15], a[44:47], v[60:63]
    ds_read_b64_tr_b16 a[4:5], v8 offset:192
    v_mfma_f32_16x16x32_bf16 v[64:67], a[12:15], a[48:51], v[64:67]
    ds_read_b64_tr_b16 a[6:7], v8 offset:3776
    s_waitcnt lgkmcnt(10)
    v_mfma_f32_16x16x32_bf16 v[68:71], a[16:19], a[44:47], v[68:71]
    ds_read_b64_tr_b16 a[8:9], v8 offset:7360
    v_mfma_f32_16x16x32_bf16 v[72:75], a[16:19], a[48:51], v[72:75]
    ds_read_b64_tr_b16 a[10:11], v8 offset:10944
    s_barrier
    v_add_u32 v7, 135168, v6
    v_add_u32 v10, 135168, v9
    ds_read_b128 a[36:39], v10 offset:0
    ds_read_b128 a[40:43], v10 offset:1024
    v_mfma_f32_16x16x32_bf16 v[76:79], a[20:23], a[44:47], v[76:79]
    ds_read_b64_tr_b16 a[12:13], v7 offset:0
    v_mfma_f32_16x16x32_bf16 v[80:83], a[20:23], a[48:51], v[80:83]
    ds_read_b64_tr_b16 a[14:15], v7 offset:3584
    s_waitcnt lgkmcnt(12)
    v_mfma_f32_16x16x32_bf16 v[84:87], a[24:27], a[44:47], v[84:87]
    ds_read_b64_tr_b16 a[16:17], v7 offset:7168
    v_mfma_f32_16x16x32_bf16 v[88:91], a[24:27], a[48:51], v[88:91]
    ds_read_b64_tr_b16 a[18:19], v7 offset:10752
    v_mfma_f32_16x16x32_bf16 v[92:95], a[28:31], a[44:47], v[92:95]
    ds_read_b64_tr_b16 a[20:21], v7 offset:32
    v_mfma_f32_16x16x32_bf16 v[96:99], a[28:31], a[48:51], v[96:99]
    ds_read_b64_tr_b16 a[22:23], v7 offset:3616
    s_waitcnt lgkmcnt(12)
    v_mfma_f32_16x16x32_bf16 v[100:103], a[32:35], a[44:47], v[100:103]
    ds_read_b64_tr_b16 a[24:25], v7 offset:7200
    v_mfma_f32_16x16x32_bf16 v[104:107], a[32:35], a[48:51], v[104:107]
    ds_read_b64_tr_b16 a[26:27], v7 offset:10784
    v_mfma_f32_16x16x32_bf16 v[108:111], a[0:3], a[44:47], v[108:111]
    ds_read_b64_tr_b16 a[28:29], v7 offset:64
    v_mfma_f32_16x16x32_bf16 v[112:115], a[0:3], a[48:51], v[112:115]
    ds_read_b64_tr_b16 a[30:31], v7 offset:3648
    s_waitcnt lgkmcnt(12)
    v_mfma_f32_16x16x32_bf16 v[116:119], a[4:7], a[44:47], v[116:119]
    ds_read_b64_tr_b16 a[32:33], v7 offset:7232
    v_mfma_f32_16x16x32_bf16 v[120:123], a[4:7], a[48:51], v[120:123]
    ds_read_b64_tr_b16 a[34:35], v7 offset:10816
    v_mfma_f32_16x16x32_bf16 v[124:127], a[8:11], a[44:47], v[124:127]
    ds_read_b64_tr_b16 a[0:1], v7 offset:96
    v_mfma_f32_16x16x32_bf16 v[128:131], a[8:11], a[48:51], v[128:131]
    ds_read_b64_tr_b16 a[2:3], v7 offset:3680
    s_waitcnt lgkmcnt(10)
    v_mfma_f32_16x16x32_bf16 v[20:23], a[12:15], a[36:39], v[20:23]
    ds_read_b64_tr_b16 a[4:5], v7 offset:7264
    v_mfma_f32_16x16x32_bf16 v[24:27], a[12:15], a[40:43], v[24:27]
    ds_read_b64_tr_b16 a[6:7], v7 offset:10848
    v_mfma_f32_16x16x32_bf16 v[28:31], a[16:19], a[36:39], v[28:31]
    ds_read_b64_tr_b16 a[8:9], v7 offset:128
    v_mfma_f32_16x16x32_bf16 v[32:35], a[16:19], a[40:43], v[32:35]
    ds_read_b64_tr_b16 a[10:11], v7 offset:3712
    s_waitcnt lgkmcnt(10)
    v_mfma_f32_16x16x32_bf16 v[36:39], a[20:23], a[36:39], v[36:39]
    ds_read_b64_tr_b16 a[12:13], v7 offset:7296
    v_mfma_f32_16x16x32_bf16 v[40:43], a[20:23], a[40:43], v[40:43]
    ds_read_b64_tr_b16 a[14:15], v7 offset:10880
    v_mfma_f32_16x16x32_bf16 v[44:47], a[24:27], a[36:39], v[44:47]
    ds_read_b64_tr_b16 a[16:17], v7 offset:160
    v_mfma_f32_16x16x32_bf16 v[48:51], a[24:27], a[40:43], v[48:51]
    ds_read_b64_tr_b16 a[18:19], v7 offset:3744
    s_waitcnt lgkmcnt(10)
    v_mfma_f32_16x16x32_bf16 v[52:55], a[28:31], a[36:39], v[52:55]
    ds_read_b64_tr_b16 a[20:21], v7 offset:7328
    v_mfma_f32_16x16x32_bf16 v[56:59], a[28:31], a[40:43], v[56:59]
    ds_read_b64_tr_b16 a[22:23], v7 offset:10912
    v_mfma_f32_16x16x32_bf16 v[60:63], a[32:35], a[36:39], v[60:63]
    ds_read_b64_tr_b16 a[24:25], v7 offset:192
    v_mfma_f32_16x16x32_bf16 v[64:67], a[32:35], a[40:43], v[64:67]
    ds_read_b64_tr_b16 a[26:27], v7 offset:3776
    s_waitcnt lgkmcnt(10)
    v_mfma_f32_16x16x32_bf16 v[68:71], a[0:3], a[36:39], v[68:71]
    ds_read_b64_tr_b16 a[28:29], v7 offset:7360
    v_mfma_f32_16x16x32_bf16 v[72:75], a[0:3], a[40:43], v[72:75]
    ds_read_b64_tr_b16 a[30:31], v7 offset:10944
    v_add_u32 v8, 0, v6
    v_add_u32 v11, 0, v9
    ds_read_b128 a[44:47], v11 offset:0
    ds_read_b128 a[48:51], v11 offset:1024
    v_mfma_f32_16x16x32_bf16 v[76:79], a[4:7], a[36:39], v[76:79]
    ds_read_b64_tr_b16 a[32:33], v8 offset:0
    v_mfma_f32_16x16x32_bf16 v[80:83], a[4:7], a[40:43], v[80:83]
    ds_read_b64_tr_b16 a[34:35], v8 offset:3584
    s_waitcnt lgkmcnt(12)
    v_mfma_f32_16x16x32_bf16 v[84:87], a[8:11], a[36:39], v[84:87]
    ds_read_b64_tr_b16 a[0:1], v8 offset:7168
    v_mfma_f32_16x16x32_bf16 v[88:91], a[8:11], a[40:43], v[88:91]
    ds_read_b64_tr_b16 a[2:3], v8 offset:10752
    v_mfma_f32_16x16x32_bf16 v[92:95], a[12:15], a[36:39], v[92:95]
    ds_read_b64_tr_b16 a[4:5], v8 offset:32
    v_mfma_f32_16x16x32_bf16 v[96:99], a[12:15], a[40:43], v[96:99]
    ds_read_b64_tr_b16 a[6:7], v8 offset:3616
    s_waitcnt lgkmcnt(12)
    v_mfma_f32_16x16x32_bf16 v[100:103], a[16:19], a[36:39], v[100:103]
    ds_read_b64_tr_b16 a[8:9], v8 offset:7200
    v_mfma_f32_16x16x32_bf16 v[104:107], a[16:19], a[40:43], v[104:107]
    ds_read_b64_tr_b16 a[10:11], v8 offset:10784
    v_mfma_f32_16x16x32_bf16 v[108:111], a[20:23], a[36:39], v[108:111]
    ds_read_b64_tr_b16 a[12:13], v8 offset:64
    v_mfma_f32_16x16x32_bf16 v[112:115], a[20:23], a[40:43], v[112:115]
    ds_read_b64_tr_b16 a[14:15], v8 offset:3648
    s_waitcnt lgkmcnt(12)
    v_mfma_f32_16x16x32_bf16 v[116:119], a[24:27], a[36:39], v[116:119]
    ds_read_b64_tr_b16 a[16:17], v8 offset:7232
    v_mfma_f32_16x16x32_bf16 v[120:123], a[24:27], a[40:43], v[120:123]
    ds_read_b64_tr_b16 a[18:19], v8 offset:10816
    v_mfma_f32_16x16x32_bf16 v[124:127], a[28:31], a[36:39], v[124:127]
    ds_read_b64_tr_b16 a[20:21], v8 offset:96
    v_mfma_f32_16x16x32_bf16 v[128:131], a[28:31], a[40:43], v[128:131]
    ds_read_b64_tr_b16 a[22:23], v8 offset:3680
    s_waitcnt lgkmcnt(10)
    v_mfma_f32_16x16x32_bf16 v[20:23], a[32:35], a[44:47], v[20:23]
    ds_read_b64_tr_b16 a[24:25], v8 offset:7264
    v_mfma_f32_16x16x32_bf16 v[24:27], a[32:35], a[48:51], v[24:27]
    ds_read_b64_tr_b16 a[26:27], v8 offset:10848
    v_mfma_f32_16x16x32_bf16 v[28:31], a[0:3], a[44:47], v[28:31]
    ds_read_b64_tr_b16 a[28:29], v8 offset:128
    v_mfma_f32_16x16x32_bf16 v[32:35], a[0:3], a[48:51], v[32:35]
    ds_read_b64_tr_b16 a[30:31], v8 offset:3712
    s_waitcnt lgkmcnt(10)
    v_mfma_f32_16x16x32_bf16 v[36:39], a[4:7], a[44:47], v[36:39]
    ds_read_b64_tr_b16 a[32:33], v8 offset:7296
    v_mfma_f32_16x16x32_bf16 v[40:43], a[4:7], a[48:51], v[40:43]
    ds_read_b64_tr_b16 a[34:35], v8 offset:10880
    v_mfma_f32_16x16x32_bf16 v[44:47], a[8:11], a[44:47], v[44:47]
    ds_read_b64_tr_b16 a[0:1], v8 offset:160
    v_mfma_f32_16x16x32_bf16 v[48:51], a[8:11], a[48:51], v[48:51]
    ds_read_b64_tr_b16 a[2:3], v8 offset:3744
    s_waitcnt lgkmcnt(10)
    v_mfma_f32_16x16x32_bf16 v[52:55], a[12:15], a[44:47], v[52:55]
    ds_read_b64_tr_b16 a[4:5], v8 offset:7328
    v_mfma_f32_16x16x32_bf16 v[56:59], a[12:15], a[48:51], v[56:59]
    ds_read_b64_tr_b16 a[6:7], v8 offset:10912
    v_mfma_f32_16x16x32_bf16 v[60:63], a[16:19], a[44:47], v[60:63]
    ds_read_b64_tr_b16 a[8:9], v8 offset:192
    v_mfma_f32_16x16x32_bf16 v[64:67], a[16:19], a[48:51], v[64:67]
    ds_read_b64_tr_b16 a[10:11], v8 offset:3776
    s_waitcnt lgkmcnt(10)
    v_mfma_f32_16x16x32_bf16 v[68:71], a[20:23], a[44:47], v[68:71]
    ds_read_b64_tr_b16 a[12:13], v8 offset:7360
    v_mfma_f32_16x16x32_bf16 v[72:75], a[20:23], a[48:51], v[72:75]
    ds_read_b64_tr_b16 a[14:15], v8 offset:10944
    s_barrier
    v_add_u32 v7, 22528, v6
    v_add_u32 v10, 22528, v9
    ds_read_b128 a[36:39], v10 offset:0
    ds_read_b128 a[40:43], v10 offset:1024
    v_mfma_f32_16x16x32_bf16 v[76:79], a[24:27], a[44:47], v[76:79]
    ds_read_b64_tr_b16 a[16:17], v7 offset:0
    v_mfma_f32_16x16x32_bf16 v[80:83], a[24:27], a[48:51], v[80:83]
    ds_read_b64_tr_b16 a[18:19], v7 offset:3584
    s_waitcnt lgkmcnt(12)
    v_mfma_f32_16x16x32_bf16 v[84:87], a[28:31], a[44:47], v[84:87]
    ds_read_b64_tr_b16 a[20:21], v7 offset:7168
    v_mfma_f32_16x16x32_bf16 v[88:91], a[28:31], a[48:51], v[88:91]
    ds_read_b64_tr_b16 a[22:23], v7 offset:10752
    v_mfma_f32_16x16x32_bf16 v[92:95], a[32:35], a[44:47], v[92:95]
    ds_read_b64_tr_b16 a[24:25], v7 offset:32
    v_mfma_f32_16x16x32_bf16 v[96:99], a[32:35], a[48:51], v[96:99]
    ds_read_b64_tr_b16 a[26:27], v7 offset:3616
    s_waitcnt lgkmcnt(12)
    v_mfma_f32_16x16x32_bf16 v[100:103], a[0:3], a[44:47], v[100:103]
    ds_read_b64_tr_b16 a[28:29], v7 offset:7200
    v_mfma_f32_16x16x32_bf16 v[104:107], a[0:3], a[48:51], v[104:107]
    ds_read_b64_tr_b16 a[30:31], v7 offset:10784
    v_mfma_f32_16x16x32_bf16 v[108:111], a[4:7], a[44:47], v[108:111]
    ds_read_b64_tr_b16 a[32:33], v7 offset:64
    v_mfma_f32_16x16x32_bf16 v[112:115], a[4:7], a[48:51], v[112:115]
    ds_read_b64_tr_b16 a[34:35], v7 offset:3648
    s_waitcnt lgkmcnt(12)
    v_mfma_f32_16x16x32_bf16 v[116:119], a[8:11], a[44:47], v[116:119]
    ds_read_b64_tr_b16 a[0:1], v7 offset:7232
    v_mfma_f32_16x16x32_bf16 v[120:123], a[8:11], a[48:51], v[120:123]
    ds_read_b64_tr_b16 a[2:3], v7 offset:10816
    v_mfma_f32_16x16x32_bf16 v[124:127], a[12:15], a[44:47], v[124:127]
    ds_read_b64_tr_b16 a[4:5], v7 offset:96
    v_mfma_f32_16x16x32_bf16 v[128:131], a[12:15], a[48:51], v[128:131]
    ds_read_b64_tr_b16 a[6:7], v7 offset:3680
    s_waitcnt lgkmcnt(10)
    v_mfma_f32_16x16x32_bf16 v[20:23], a[16:19], a[36:39], v[20:23]
    ds_read_b64_tr_b16 a[8:9], v7 offset:7264
    v_mfma_f32_16x16x32_bf16 v[24:27], a[16:19], a[40:43], v[24:27]
    ds_read_b64_tr_b16 a[10:11], v7 offset:10848
    v_mfma_f32_16x16x32_bf16 v[28:31], a[20:23], a[36:39], v[28:31]
    ds_read_b64_tr_b16 a[12:13], v7 offset:128
    v_mfma_f32_16x16x32_bf16 v[32:35], a[20:23], a[40:43], v[32:35]
    ds_read_b64_tr_b16 a[14:15], v7 offset:3712
    s_waitcnt lgkmcnt(10)
    v_mfma_f32_16x16x32_bf16 v[36:39], a[24:27], a[36:39], v[36:39]
    ds_read_b64_tr_b16 a[16:17], v7 offset:7296
    v_mfma_f32_16x16x32_bf16 v[40:43], a[24:27], a[40:43], v[40:43]
    ds_read_b64_tr_b16 a[18:19], v7 offset:10880
    v_mfma_f32_16x16x32_bf16 v[44:47], a[28:31], a[36:39], v[44:47]
    ds_read_b64_tr_b16 a[20:21], v7 offset:160
    v_mfma_f32_16x16x32_bf16 v[48:51], a[28:31], a[40:43], v[48:51]
    ds_read_b64_tr_b16 a[22:23], v7 offset:3744
    s_waitcnt lgkmcnt(10)
    v_mfma_f32_16x16x32_bf16 v[52:55], a[32:35], a[36:39], v[52:55]
    ds_read_b64_tr_b16 a[24:25], v7 offset:7328
    v_mfma_f32_16x16x32_bf16 v[56:59], a[32:35], a[40:43], v[56:59]
    ds_read_b64_tr_b16 a[26:27], v7 offset:10912
    v_mfma_f32_16x16x32_bf16 v[60:63], a[0:3], a[36:39], v[60:63]
    ds_read_b64_tr_b16 a[28:29], v7 offset:192
    v_mfma_f32_16x16x32_bf16 v[64:67], a[0:3], a[40:43], v[64:67]
    ds_read_b64_tr_b16 a[30:31], v7 offset:3776
    s_waitcnt lgkmcnt(10)
    v_mfma_f32_16x16x32_bf16 v[68:71], a[4:7], a[36:39], v[68:71]
    ds_read_b64_tr_b16 a[32:33], v7 offset:7360
    v_mfma_f32_16x16x32_bf16 v[72:75], a[4:7], a[40:43], v[72:75]
    ds_read_b64_tr_b16 a[34:35], v7 offset:10944
    v_add_u32 v8, 45056, v6
    v_add_u32 v11, 45056, v9
    ds_read_b128 a[44:47], v11 offset:0
    ds_read_b128 a[48:51], v11 offset:1024
    v_mfma_f32_16x16x32_bf16 v[76:79], a[8:11], a[36:39], v[76:79]
    ds_read_b64_tr_b16 a[0:1], v8 offset:0
    v_mfma_f32_16x16x32_bf16 v[80:83], a[8:11], a[40:43], v[80:83]
    ds_read_b64_tr_b16 a[2:3], v8 offset:3584
    s_waitcnt lgkmcnt(12)
    v_mfma_f32_16x16x32_bf16 v[84:87], a[12:15], a[36:39], v[84:87]
    ds_read_b64_tr_b16 a[4:5], v8 offset:7168
    v_mfma_f32_16x16x32_bf16 v[88:91], a[12:15], a[40:43], v[88:91]
    ds_read_b64_tr_b16 a[6:7], v8 offset:10752
    v_mfma_f32_16x16x32_bf16 v[92:95], a[16:19], a[36:39], v[92:95]
    ds_read_b64_tr_b16 a[8:9], v8 offset:32
    v_mfma_f32_16x16x32_bf16 v[96:99], a[16:19], a[40:43], v[96:99]
    ds_read_b64_tr_b16 a[10:11], v8 offset:3616
    s_waitcnt lgkmcnt(12)
    v_mfma_f32_16x16x32_bf16 v[100:103], a[20:23], a[36:39], v[100:103]
    ds_read_b64_tr_b16 a[12:13], v8 offset:7200
    v_mfma_f32_16x16x32_bf16 v[104:107], a[20:23], a[40:43], v[104:107]
    ds_read_b64_tr_b16 a[14:15], v8 offset:10784
    v_mfma_f32_16x16x32_bf16 v[108:111], a[24:27], a[36:39], v[108:111]
    ds_read_b64_tr_b16 a[16:17], v8 offset:64
    v_mfma_f32_16x16x32_bf16 v[112:115], a[24:27], a[40:43], v[112:115]
    ds_read_b64_tr_b16 a[18:19], v8 offset:3648
    s_waitcnt lgkmcnt(12)
    v_mfma_f32_16x16x32_bf16 v[116:119], a[28:31], a[36:39], v[116:119]
    ds_read_b64_tr_b16 a[20:21], v8 offset:7232
    v_mfma_f32_16x16x32_bf16 v[120:123], a[28:31], a[40:43], v[120:123]
    ds_read_b64_tr_b16 a[22:23], v8 offset:10816
    v_mfma_f32_16x16x32_bf16 v[124:127], a[32:35], a[36:39], v[124:127]
    ds_read_b64_tr_b16 a[24:25], v8 offset:96
    v_mfma_f32_16x16x32_bf16 v[128:131], a[32:35], a[40:43], v[128:131]
    ds_read_b64_tr_b16 a[26:27], v8 offset:3680
    s_waitcnt lgkmcnt(10)
    v_mfma_f32_16x16x32_bf16 v[20:23], a[0:3], a[44:47], v[20:23]
    ds_read_b64_tr_b16 a[28:29], v8 offset:7264
    v_mfma_f32_16x16x32_bf16 v[24:27], a[0:3], a[48:51], v[24:27]
    ds_read_b64_tr_b16 a[30:31], v8 offset:10848
    v_mfma_f32_16x16x32_bf16 v[28:31], a[4:7], a[44:47], v[28:31]
    ds_read_b64_tr_b16 a[32:33], v8 offset:128
    v_mfma_f32_16x16x32_bf16 v[32:35], a[4:7], a[48:51], v[32:35]
    ds_read_b64_tr_b16 a[34:35], v8 offset:3712
    s_waitcnt lgkmcnt(10)
    v_mfma_f32_16x16x32_bf16 v[36:39], a[8:11], a[44:47], v[36:39]
    ds_read_b64_tr_b16 a[0:1], v8 offset:7296
    v_mfma_f32_16x16x32_bf16 v[40:43], a[8:11], a[48:51], v[40:43]
    ds_read_b64_tr_b16 a[2:3], v8 offset:10880
    v_mfma_f32_16x16x32_bf16 v[44:47], a[12:15], a[44:47], v[44:47]
    ds_read_b64_tr_b16 a[4:5], v8 offset:160
    v_mfma_f32_16x16x32_bf16 v[48:51], a[12:15], a[48:51], v[48:51]
    ds_read_b64_tr_b16 a[6:7], v8 offset:3744
    s_waitcnt lgkmcnt(10)
    v_mfma_f32_16x16x32_bf16 v[52:55], a[16:19], a[44:47], v[52:55]
    ds_read_b64_tr_b16 a[8:9], v8 offset:7328
    v_mfma_f32_16x16x32_bf16 v[56:59], a[16:19], a[48:51], v[56:59]
    ds_read_b64_tr_b16 a[10:11], v8 offset:10912
    v_mfma_f32_16x16x32_bf16 v[60:63], a[20:23], a[44:47], v[60:63]
    ds_read_b64_tr_b16 a[12:13], v8 offset:192
    v_mfma_f32_16x16x32_bf16 v[64:67], a[20:23], a[48:51], v[64:67]
    ds_read_b64_tr_b16 a[14:15], v8 offset:3776
    s_waitcnt lgkmcnt(10)
    v_mfma_f32_16x16x32_bf16 v[68:71], a[24:27], a[44:47], v[68:71]
    ds_read_b64_tr_b16 a[16:17], v8 offset:7360
    v_mfma_f32_16x16x32_bf16 v[72:75], a[24:27], a[48:51], v[72:75]
    ds_read_b64_tr_b16 a[18:19], v8 offset:10944
    s_barrier
    v_add_u32 v7, 67584, v6
    v_add_u32 v10, 67584, v9
    ds_read_b128 a[36:39], v10 offset:0
    ds_read_b128 a[40:43], v10 offset:1024
    v_mfma_f32_16x16x32_bf16 v[76:79], a[28:31], a[44:47], v[76:79]
    ds_read_b64_tr_b16 a[20:21], v7 offset:0
    v_mfma_f32_16x16x32_bf16 v[80:83], a[28:31], a[48:51], v[80:83]
    ds_read_b64_tr_b16 a[22:23], v7 offset:3584
    s_waitcnt lgkmcnt(12)
    v_mfma_f32_16x16x32_bf16 v[84:87], a[32:35], a[44:47], v[84:87]
    ds_read_b64_tr_b16 a[24:25], v7 offset:7168
    v_mfma_f32_16x16x32_bf16 v[88:91], a[32:35], a[48:51], v[88:91]
    ds_read_b64_tr_b16 a[26:27], v7 offset:10752
    v_mfma_f32_16x16x32_bf16 v[92:95], a[0:3], a[44:47], v[92:95]
    ds_read_b64_tr_b16 a[28:29], v7 offset:32
    v_mfma_f32_16x16x32_bf16 v[96:99], a[0:3], a[48:51], v[96:99]
    ds_read_b64_tr_b16 a[30:31], v7 offset:3616
    s_waitcnt lgkmcnt(12)
    v_mfma_f32_16x16x32_bf16 v[100:103], a[4:7], a[44:47], v[100:103]
    ds_read_b64_tr_b16 a[32:33], v7 offset:7200
    v_mfma_f32_16x16x32_bf16 v[104:107], a[4:7], a[48:51], v[104:107]
    ds_read_b64_tr_b16 a[34:35], v7 offset:10784
    v_mfma_f32_16x16x32_bf16 v[108:111], a[8:11], a[44:47], v[108:111]
    ds_read_b64_tr_b16 a[0:1], v7 offset:64
    v_mfma_f32_16x16x32_bf16 v[112:115], a[8:11], a[48:51], v[112:115]
    ds_read_b64_tr_b16 a[2:3], v7 offset:3648
    s_waitcnt lgkmcnt(12)
    v_mfma_f32_16x16x32_bf16 v[116:119], a[12:15], a[44:47], v[116:119]
    ds_read_b64_tr_b16 a[4:5], v7 offset:7232
    v_mfma_f32_16x16x32_bf16 v[120:123], a[12:15], a[48:51], v[120:123]
    ds_read_b64_tr_b16 a[6:7], v7 offset:10816
    v_mfma_f32_16x16x32_bf16 v[124:127], a[16:19], a[44:47], v[124:127]
    ds_read_b64_tr_b16 a[8:9], v7 offset:96
    v_mfma_f32_16x16x32_bf16 v[128:131], a[16:19], a[48:51], v[128:131]
    ds_read_b64_tr_b16 a[10:11], v7 offset:3680
    s_waitcnt lgkmcnt(10)
    v_mfma_f32_16x16x32_bf16 v[20:23], a[20:23], a[36:39], v[20:23]
    ds_read_b64_tr_b16 a[12:13], v7 offset:7264
    v_mfma_f32_16x16x32_bf16 v[24:27], a[20:23], a[40:43], v[24:27]
    ds_read_b64_tr_b16 a[14:15], v7 offset:10848
    v_mfma_f32_16x16x32_bf16 v[28:31], a[24:27], a[36:39], v[28:31]
    ds_read_b64_tr_b16 a[16:17], v7 offset:128
    v_mfma_f32_16x16x32_bf16 v[32:35], a[24:27], a[40:43], v[32:35]
    ds_read_b64_tr_b16 a[18:19], v7 offset:3712
    s_waitcnt lgkmcnt(10)
    v_mfma_f32_16x16x32_bf16 v[36:39], a[28:31], a[36:39], v[36:39]
    ds_read_b64_tr_b16 a[20:21], v7 offset:7296
    v_mfma_f32_16x16x32_bf16 v[40:43], a[28:31], a[40:43], v[40:43]
    ds_read_b64_tr_b16 a[22:23], v7 offset:10880
    v_mfma_f32_16x16x32_bf16 v[44:47], a[32:35], a[36:39], v[44:47]
    ds_read_b64_tr_b16 a[24:25], v7 offset:160
    v_mfma_f32_16x16x32_bf16 v[48:51], a[32:35], a[40:43], v[48:51]
    ds_read_b64_tr_b16 a[26:27], v7 offset:3744
    s_waitcnt lgkmcnt(10)
    v_mfma_f32_16x16x32_bf16 v[52:55], a[0:3], a[36:39], v[52:55]
    ds_read_b64_tr_b16 a[28:29], v7 offset:7328
    v_mfma_f32_16x16x32_bf16 v[56:59], a[0:3], a[40:43], v[56:59]
    ds_read_b64_tr_b16 a[30:31], v7 offset:10912
    v_mfma_f32_16x16x32_bf16 v[60:63], a[4:7], a[36:39], v[60:63]
    ds_read_b64_tr_b16 a[32:33], v7 offset:192
    v_mfma_f32_16x16x32_bf16 v[64:67], a[4:7], a[40:43], v[64:67]
    ds_read_b64_tr_b16 a[34:35], v7 offset:3776
    s_waitcnt lgkmcnt(10)
    v_mfma_f32_16x16x32_bf16 v[68:71], a[8:11], a[36:39], v[68:71]
    ds_read_b64_tr_b16 a[0:1], v7 offset:7360
    v_mfma_f32_16x16x32_bf16 v[72:75], a[8:11], a[40:43], v[72:75]
    ds_read_b64_tr_b16 a[2:3], v7 offset:10944
    v_add_u32 v8, 90112, v6
    v_add_u32 v11, 90112, v9
    ds_read_b128 a[44:47], v11 offset:0
    ds_read_b128 a[48:51], v11 offset:1024
    v_mfma_f32_16x16x32_bf16 v[76:79], a[12:15], a[36:39], v[76:79]
    ds_read_b64_tr_b16 a[4:5], v8 offset:0
    v_mfma_f32_16x16x32_bf16 v[80:83], a[12:15], a[40:43], v[80:83]
    ds_read_b64_tr_b16 a[6:7], v8 offset:3584
    s_waitcnt lgkmcnt(12)
    v_mfma_f32_16x16x32_bf16 v[84:87], a[16:19], a[36:39], v[84:87]
    ds_read_b64_tr_b16 a[8:9], v8 offset:7168
    v_mfma_f32_16x16x32_bf16 v[88:91], a[16:19], a[40:43], v[88:91]
    ds_read_b64_tr_b16 a[10:11], v8 offset:10752
    v_mfma_f32_16x16x32_bf16 v[92:95], a[20:23], a[36:39], v[92:95]
    ds_read_b64_tr_b16 a[12:13], v8 offset:32
    v_mfma_f32_16x16x32_bf16 v[96:99], a[20:23], a[40:43], v[96:99]
    ds_read_b64_tr_b16 a[14:15], v8 offset:3616
    s_waitcnt lgkmcnt(12)
    v_mfma_f32_16x16x32_bf16 v[100:103], a[24:27], a[36:39], v[100:103]
    ds_read_b64_tr_b16 a[16:17], v8 offset:7200
    v_mfma_f32_16x16x32_bf16 v[104:107], a[24:27], a[40:43], v[104:107]
    ds_read_b64_tr_b16 a[18:19], v8 offset:10784
    v_mfma_f32_16x16x32_bf16 v[108:111], a[28:31], a[36:39], v[108:111]
    ds_read_b64_tr_b16 a[20:21], v8 offset:64
    v_mfma_f32_16x16x32_bf16 v[112:115], a[28:31], a[40:43], v[112:115]
    ds_read_b64_tr_b16 a[22:23], v8 offset:3648
    s_waitcnt lgkmcnt(12)
    v_mfma_f32_16x16x32_bf16 v[116:119], a[32:35], a[36:39], v[116:119]
    ds_read_b64_tr_b16 a[24:25], v8 offset:7232
    v_mfma_f32_16x16x32_bf16 v[120:123], a[32:35], a[40:43], v[120:123]
    ds_read_b64_tr_b16 a[26:27], v8 offset:10816
    v_mfma_f32_16x16x32_bf16 v[124:127], a[0:3], a[36:39], v[124:127]
    ds_read_b64_tr_b16 a[28:29], v8 offset:96
    v_mfma_f32_16x16x32_bf16 v[128:131], a[0:3], a[40:43], v[128:131]
    ds_read_b64_tr_b16 a[30:31], v8 offset:3680
    s_waitcnt lgkmcnt(10)
    v_mfma_f32_16x16x32_bf16 v[20:23], a[4:7], a[44:47], v[20:23]
    ds_read_b64_tr_b16 a[32:33], v8 offset:7264
    v_mfma_f32_16x16x32_bf16 v[24:27], a[4:7], a[48:51], v[24:27]
    ds_read_b64_tr_b16 a[34:35], v8 offset:10848
    v_mfma_f32_16x16x32_bf16 v[28:31], a[8:11], a[44:47], v[28:31]
    ds_read_b64_tr_b16 a[0:1], v8 offset:128
    v_mfma_f32_16x16x32_bf16 v[32:35], a[8:11], a[48:51], v[32:35]
    ds_read_b64_tr_b16 a[2:3], v8 offset:3712
    s_waitcnt lgkmcnt(10)
    v_mfma_f32_16x16x32_bf16 v[36:39], a[12:15], a[44:47], v[36:39]
    ds_read_b64_tr_b16 a[4:5], v8 offset:7296
    v_mfma_f32_16x16x32_bf16 v[40:43], a[12:15], a[48:51], v[40:43]
    ds_read_b64_tr_b16 a[6:7], v8 offset:10880
    v_mfma_f32_16x16x32_bf16 v[44:47], a[16:19], a[44:47], v[44:47]
    ds_read_b64_tr_b16 a[8:9], v8 offset:160
    v_mfma_f32_16x16x32_bf16 v[48:51], a[16:19], a[48:51], v[48:51]
    ds_read_b64_tr_b16 a[10:11], v8 offset:3744
    s_waitcnt lgkmcnt(10)
    v_mfma_f32_16x16x32_bf16 v[52:55], a[20:23], a[44:47], v[52:55]
    ds_read_b64_tr_b16 a[12:13], v8 offset:7328
    v_mfma_f32_16x16x32_bf16 v[56:59], a[20:23], a[48:51], v[56:59]
    ds_read_b64_tr_b16 a[14:15], v8 offset:10912
    v_mfma_f32_16x16x32_bf16 v[60:63], a[24:27], a[44:47], v[60:63]
    ds_read_b64_tr_b16 a[16:17], v8 offset:192
    v_mfma_f32_16x16x32_bf16 v[64:67], a[24:27], a[48:51], v[64:67]
    ds_read_b64_tr_b16 a[18:19], v8 offset:3776
    s_waitcnt lgkmcnt(10)
    v_mfma_f32_16x16x32_bf16 v[68:71], a[28:31], a[44:47], v[68:71]
    ds_read_b64_tr_b16 a[20:21], v8 offset:7360
    v_mfma_f32_16x16x32_bf16 v[72:75], a[28:31], a[48:51], v[72:75]
    ds_read_b64_tr_b16 a[22:23], v8 offset:10944
    s_barrier
    v_add_u32 v7, 112640, v6
    v_add_u32 v10, 112640, v9
    ds_read_b128 a[36:39], v10 offset:0
    ds_read_b128 a[40:43], v10 offset:1024
    v_mfma_f32_16x16x32_bf16 v[76:79], a[32:35], a[44:47], v[76:79]
    ds_read_b64_tr_b16 a[24:25], v7 offset:0
    v_mfma_f32_16x16x32_bf16 v[80:83], a[32:35], a[48:51], v[80:83]
    ds_read_b64_tr_b16 a[26:27], v7 offset:3584
    s_waitcnt lgkmcnt(12)
    v_mfma_f32_16x16x32_bf16 v[84:87], a[0:3], a[44:47], v[84:87]
    ds_read_b64_tr_b16 a[28:29], v7 offset:7168
    v_mfma_f32_16x16x32_bf16 v[88:91], a[0:3], a[48:51], v[88:91]
    ds_read_b64_tr_b16 a[30:31], v7 offset:10752
    v_mfma_f32_16x16x32_bf16 v[92:95], a[4:7], a[44:47], v[92:95]
    ds_read_b64_tr_b16 a[32:33], v7 offset:32
    v_mfma_f32_16x16x32_bf16 v[96:99], a[4:7], a[48:51], v[96:99]
    ds_read_b64_tr_b16 a[34:35], v7 offset:3616
    s_waitcnt lgkmcnt(12)
    v_mfma_f32_16x16x32_bf16 v[100:103], a[8:11], a[44:47], v[100:103]
    ds_read_b64_tr_b16 a[0:1], v7 offset:7200
    v_mfma_f32_16x16x32_bf16 v[104:107], a[8:11], a[48:51], v[104:107]
    ds_read_b64_tr_b16 a[2:3], v7 offset:10784
    v_mfma_f32_16x16x32_bf16 v[108:111], a[12:15], a[44:47], v[108:111]
    ds_read_b64_tr_b16 a[4:5], v7 offset:64
    v_mfma_f32_16x16x32_bf16 v[112:115], a[12:15], a[48:51], v[112:115]
    ds_read_b64_tr_b16 a[6:7], v7 offset:3648
    s_waitcnt lgkmcnt(12)
    v_mfma_f32_16x16x32_bf16 v[116:119], a[16:19], a[44:47], v[116:119]
    ds_read_b64_tr_b16 a[8:9], v7 offset:7232
    v_mfma_f32_16x16x32_bf16 v[120:123], a[16:19], a[48:51], v[120:123]
    ds_read_b64_tr_b16 a[10:11], v7 offset:10816
    v_mfma_f32_16x16x32_bf16 v[124:127], a[20:23], a[44:47], v[124:127]
    ds_read_b64_tr_b16 a[12:13], v7 offset:96
    v_mfma_f32_16x16x32_bf16 v[128:131], a[20:23], a[48:51], v[128:131]
    ds_read_b64_tr_b16 a[14:15], v7 offset:3680
    s_waitcnt lgkmcnt(10)
    v_mfma_f32_16x16x32_bf16 v[20:23], a[24:27], a[36:39], v[20:23]
    ds_read_b64_tr_b16 a[16:17], v7 offset:7264
    v_mfma_f32_16x16x32_bf16 v[24:27], a[24:27], a[40:43], v[24:27]
    ds_read_b64_tr_b16 a[18:19], v7 offset:10848
    v_mfma_f32_16x16x32_bf16 v[28:31], a[28:31], a[36:39], v[28:31]
    ds_read_b64_tr_b16 a[20:21], v7 offset:128
    v_mfma_f32_16x16x32_bf16 v[32:35], a[28:31], a[40:43], v[32:35]
    ds_read_b64_tr_b16 a[22:23], v7 offset:3712
    s_waitcnt lgkmcnt(10)
    v_mfma_f32_16x16x32_bf16 v[36:39], a[32:35], a[36:39], v[36:39]
    ds_read_b64_tr_b16 a[24:25], v7 offset:7296
    v_mfma_f32_16x16x32_bf16 v[40:43], a[32:35], a[40:43], v[40:43]
    ds_read_b64_tr_b16 a[26:27], v7 offset:10880
    v_mfma_f32_16x16x32_bf16 v[44:47], a[0:3], a[36:39], v[44:47]
    ds_read_b64_tr_b16 a[28:29], v7 offset:160
    v_mfma_f32_16x16x32_bf16 v[48:51], a[0:3], a[40:43], v[48:51]
    ds_read_b64_tr_b16 a[30:31], v7 offset:3744
    s_waitcnt lgkmcnt(10)
    v_mfma_f32_16x16x32_bf16 v[52:55], a[4:7], a[36:39], v[52:55]
    ds_read_b64_tr_b16 a[32:33], v7 offset:7328
    v_mfma_f32_16x16x32_bf16 v[56:59], a[4:7], a[40:43], v[56:59]
    ds_read_b64_tr_b16 a[34:35], v7 offset:10912
    v_mfma_f32_16x16x32_bf16 v[60:63], a[8:11], a[36:39], v[60:63]
    ds_read_b64_tr_b16 a[0:1], v7 offset:192
    v_mfma_f32_16x16x32_bf16 v[64:67], a[8:11], a[40:43], v[64:67]
    ds_read_b64_tr_b16 a[2:3], v7 offset:3776
    s_waitcnt lgkmcnt(10)
    v_mfma_f32_16x16x32_bf16 v[68:71], a[12:15], a[36:39], v[68:71]
    ds_read_b64_tr_b16 a[4:5], v7 offset:7360
    v_mfma_f32_16x16x32_bf16 v[72:75], a[12:15], a[40:43], v[72:75]
    ds_read_b64_tr_b16 a[6:7], v7 offset:10944
    v_add_u32 v8, 135168, v6
    v_add_u32 v11, 135168, v9
    ds_read_b128 a[44:47], v11 offset:0
    ds_read_b128 a[48:51], v11 offset:1024
    v_mfma_f32_16x16x32_bf16 v[76:79], a[16:19], a[36:39], v[76:79]
    ds_read_b64_tr_b16 a[8:9], v8 offset:0
    v_mfma_f32_16x16x32_bf16 v[80:83], a[16:19], a[40:43], v[80:83]
    ds_read_b64_tr_b16 a[10:11], v8 offset:3584
    s_waitcnt lgkmcnt(12)
    v_mfma_f32_16x16x32_bf16 v[84:87], a[20:23], a[36:39], v[84:87]
    ds_read_b64_tr_b16 a[12:13], v8 offset:7168
    v_mfma_f32_16x16x32_bf16 v[88:91], a[20:23], a[40:43], v[88:91]
    ds_read_b64_tr_b16 a[14:15], v8 offset:10752
    v_mfma_f32_16x16x32_bf16 v[92:95], a[24:27], a[36:39], v[92:95]
    ds_read_b64_tr_b16 a[16:17], v8 offset:32
    v_mfma_f32_16x16x32_bf16 v[96:99], a[24:27], a[40:43], v[96:99]
    ds_read_b64_tr_b16 a[18:19], v8 offset:3616
    s_waitcnt lgkmcnt(12)
    v_mfma_f32_16x16x32_bf16 v[100:103], a[28:31], a[36:39], v[100:103]
    ds_read_b64_tr_b16 a[20:21], v8 offset:7200
    v_mfma_f32_16x16x32_bf16 v[104:107], a[28:31], a[40:43], v[104:107]
    ds_read_b64_tr_b16 a[22:23], v8 offset:10784
    v_mfma_f32_16x16x32_bf16 v[108:111], a[32:35], a[36:39], v[108:111]
    ds_read_b64_tr_b16 a[24:25], v8 offset:64
    v_mfma_f32_16x16x32_bf16 v[112:115], a[32:35], a[40:43], v[112:115]
    ds_read_b64_tr_b16 a[26:27], v8 offset:3648
    s_waitcnt lgkmcnt(12)
    v_mfma_f32_16x16x32_bf16 v[116:119], a[0:3], a[36:39], v[116:119]
    ds_read_b64_tr_b16 a[28:29], v8 offset:7232
    v_mfma_f32_16x16x32_bf16 v[120:123], a[0:3], a[40:43], v[120:123]
    ds_read_b64_tr_b16 a[30:31], v8 offset:10816
    v_mfma_f32_16x16x32_bf16 v[124:127], a[4:7], a[36:39], v[124:127]
    ds_read_b64_tr_b16 a[32:33], v8 offset:96
    v_mfma_f32_16x16x32_bf16 v[128:131], a[4:7], a[40:43], v[128:131]
    ds_read_b64_tr_b16 a[34:35], v8 offset:3680
    s_waitcnt lgkmcnt(10)
    v_mfma_f32_16x16x32_bf16 v[20:23], a[8:11], a[44:47], v[20:23]
    ds_read_b64_tr_b16 a[0:1], v8 offset:7264
    v_mfma_f32_16x16x32_bf16 v[24:27], a[8:11], a[48:51], v[24:27]
    ds_read_b64_tr_b16 a[2:3], v8 offset:10848
    v_mfma_f32_16x16x32_bf16 v[28:31], a[12:15], a[44:47], v[28:31]
    ds_read_b64_tr_b16 a[4:5], v8 offset:128
    v_mfma_f32_16x16x32_bf16 v[32:35], a[12:15], a[48:51], v[32:35]
    ds_read_b64_tr_b16 a[6:7], v8 offset:3712
    s_waitcnt lgkmcnt(10)
    v_mfma_f32_16x16x32_bf16 v[36:39], a[16:19], a[44:47], v[36:39]
    ds_read_b64_tr_b16 a[8:9], v8 offset:7296
    v_mfma_f32_16x16x32_bf16 v[40:43], a[16:19], a[48:51], v[40:43]
    ds_read_b64_tr_b16 a[10:11], v8 offset:10880
    v_mfma_f32_16x16x32_bf16 v[44:47], a[20:23], a[44:47], v[44:47]
    ds_read_b64_tr_b16 a[12:13], v8 offset:160
    v_mfma_f32_16x16x32_bf16 v[48:51], a[20:23], a[48:51], v[48:51]
    ds_read_b64_tr_b16 a[14:15], v8 offset:3744
    s_waitcnt lgkmcnt(10)
    v_mfma_f32_16x16x32_bf16 v[52:55], a[24:27], a[44:47], v[52:55]
    ds_read_b64_tr_b16 a[16:17], v8 offset:7328
    v_mfma_f32_16x16x32_bf16 v[56:59], a[24:27], a[48:51], v[56:59]
    ds_read_b64_tr_b16 a[18:19], v8 offset:10912
    v_mfma_f32_16x16x32_bf16 v[60:63], a[28:31], a[44:47], v[60:63]
    ds_read_b64_tr_b16 a[20:21], v8 offset:192
    v_mfma_f32_16x16x32_bf16 v[64:67], a[28:31], a[48:51], v[64:67]
    ds_read_b64_tr_b16 a[22:23], v8 offset:3776
    s_waitcnt lgkmcnt(10)
    v_mfma_f32_16x16x32_bf16 v[68:71], a[32:35], a[44:47], v[68:71]
    ds_read_b64_tr_b16 a[24:25], v8 offset:7360
    v_mfma_f32_16x16x32_bf16 v[72:75], a[32:35], a[48:51], v[72:75]
    ds_read_b64_tr_b16 a[26:27], v8 offset:10944
    s_barrier
    v_add_u32 v7, 0, v6
    v_add_u32 v10, 0, v9
    ds_read_b128 a[36:39], v10 offset:0
    ds_read_b128 a[40:43], v10 offset:1024
    v_mfma_f32_16x16x32_bf16 v[76:79], a[0:3], a[44:47], v[76:79]
    ds_read_b64_tr_b16 a[28:29], v7 offset:0
    v_mfma_f32_16x16x32_bf16 v[80:83], a[0:3], a[48:51], v[80:83]
    ds_read_b64_tr_b16 a[30:31], v7 offset:3584
    s_waitcnt lgkmcnt(12)
    v_mfma_f32_16x16x32_bf16 v[84:87], a[4:7], a[44:47], v[84:87]
    ds_read_b64_tr_b16 a[32:33], v7 offset:7168
    v_mfma_f32_16x16x32_bf16 v[88:91], a[4:7], a[48:51], v[88:91]
    ds_read_b64_tr_b16 a[34:35], v7 offset:10752
    v_add_u32 v8, 22528, v6
    v_add_u32 v11, 22528, v9
    ds_read_b128 a[52:55], v11 offset:0
    ds_read_b128 a[56:59], v11 offset:1024
    v_mfma_f32_16x16x32_bf16 v[92:95], a[8:11], a[44:47], v[92:95]
    ds_read_b64_tr_b16 a[0:1], v8 offset:0
    v_mfma_f32_16x16x32_bf16 v[96:99], a[8:11], a[48:51], v[96:99]
    ds_read_b64_tr_b16 a[2:3], v8 offset:3584
    s_waitcnt lgkmcnt(14)
    v_mfma_f32_16x16x32_bf16 v[100:103], a[12:15], a[44:47], v[100:103]
    ds_read_b64_tr_b16 a[4:5], v8 offset:7168
    v_mfma_f32_16x16x32_bf16 v[104:107], a[12:15], a[48:51], v[104:107]
    ds_read_b64_tr_b16 a[6:7], v8 offset:10752
    v_mfma_f32_16x16x32_bf16 v[108:111], a[16:19], a[44:47], v[108:111]
    ds_read_b64_tr_b16 a[8:9], v7 offset:32
    v_mfma_f32_16x16x32_bf16 v[112:115], a[16:19], a[48:51], v[112:115]
    ds_read_b64_tr_b16 a[10:11], v7 offset:3616
    s_waitcnt lgkmcnt(14)
    v_mfma_f32_16x16x32_bf16 v[116:119], a[20:23], a[44:47], v[116:119]
    ds_read_b64_tr_b16 a[12:13], v7 offset:7200
    v_mfma_f32_16x16x32_bf16 v[120:123], a[20:23], a[48:51], v[120:123]
    ds_read_b64_tr_b16 a[14:15], v7 offset:10784
    v_mfma_f32_16x16x32_bf16 v[124:127], a[24:27], a[44:47], v[124:127]
    ds_read_b64_tr_b16 a[16:17], v8 offset:32
    v_mfma_f32_16x16x32_bf16 v[128:131], a[24:27], a[48:51], v[128:131]
    ds_read_b64_tr_b16 a[18:19], v8 offset:3616
    s_waitcnt lgkmcnt(12)
    v_mfma_f32_16x16x32_bf16 v[20:23], a[28:31], a[36:39], v[20:23]
    ds_read_b64_tr_b16 a[20:21], v8 offset:7200
    v_mfma_f32_16x16x32_bf16 v[24:27], a[28:31], a[40:43], v[24:27]
    ds_read_b64_tr_b16 a[22:23], v8 offset:10784
    v_mfma_f32_16x16x32_bf16 v[28:31], a[32:35], a[36:39], v[28:31]
    ds_read_b64_tr_b16 a[24:25], v7 offset:64
    v_mfma_f32_16x16x32_bf16 v[32:35], a[32:35], a[40:43], v[32:35]
    ds_read_b64_tr_b16 a[26:27], v7 offset:3648
    s_waitcnt lgkmcnt(10)
    v_mfma_f32_16x16x32_bf16 v[20:23], a[0:3], a[52:55], v[20:23]
    ds_read_b64_tr_b16 a[28:29], v7 offset:7232
    v_mfma_f32_16x16x32_bf16 v[24:27], a[0:3], a[56:59], v[24:27]
    ds_read_b64_tr_b16 a[30:31], v7 offset:10816
    v_mfma_f32_16x16x32_bf16 v[28:31], a[4:7], a[52:55], v[28:31]
    ds_read_b64_tr_b16 a[32:33], v8 offset:64
    v_mfma_f32_16x16x32_bf16 v[32:35], a[4:7], a[56:59], v[32:35]
    ds_read_b64_tr_b16 a[34:35], v8 offset:3648
    s_waitcnt lgkmcnt(10)
    v_mfma_f32_16x16x32_bf16 v[36:39], a[8:11], a[36:39], v[36:39]
    ds_read_b64_tr_b16 a[0:1], v8 offset:7232
    v_mfma_f32_16x16x32_bf16 v[40:43], a[8:11], a[40:43], v[40:43]
    ds_read_b64_tr_b16 a[2:3], v8 offset:10816
    v_mfma_f32_16x16x32_bf16 v[44:47], a[12:15], a[36:39], v[44:47]
    ds_read_b64_tr_b16 a[4:5], v7 offset:96
    v_mfma_f32_16x16x32_bf16 v[48:51], a[12:15], a[40:43], v[48:51]
    ds_read_b64_tr_b16 a[6:7], v7 offset:3680
    s_waitcnt lgkmcnt(10)
    v_mfma_f32_16x16x32_bf16 v[36:39], a[16:19], a[52:55], v[36:39]
    ds_read_b64_tr_b16 a[8:9], v7 offset:7264
    v_mfma_f32_16x16x32_bf16 v[40:43], a[16:19], a[56:59], v[40:43]
    ds_read_b64_tr_b16 a[10:11], v7 offset:10848
    v_mfma_f32_16x16x32_bf16 v[44:47], a[20:23], a[52:55], v[44:47]
    ds_read_b64_tr_b16 a[12:13], v8 offset:96
    v_mfma_f32_16x16x32_bf16 v[48:51], a[20:23], a[56:59], v[48:51]
    ds_read_b64_tr_b16 a[14:15], v8 offset:3680
    v_max_f32 v20, 0, v20
    v_max_f32 v21, 0, v21
    v_max_f32 v22, 0, v22
    v_max_f32 v23, 0, v23
    v_pk_mul_f32 v[20:21], v[20:21], v[28:29]
    v_pk_mul_f32 v[22:23], v[22:23], v[30:31]
    v_cvt_pk_bf16_f32 v132, v20, v21
    v_cvt_pk_bf16_f32 v133, v22, v23
    v_max_f32 v24, 0, v24
    v_max_f32 v25, 0, v25
    v_max_f32 v26, 0, v26
    v_max_f32 v27, 0, v27
    v_pk_mul_f32 v[24:25], v[24:25], v[32:33]
    v_pk_mul_f32 v[26:27], v[26:27], v[34:35]
    v_cvt_pk_bf16_f32 v146, v24, v25
    v_cvt_pk_bf16_f32 v147, v26, v27
    s_bitcmp1_b32 s20, 0
    s_cbranch_scc0 F_se0
    v_mov_b32 v16, v132
    v_mov_b32 v17, v133
    v_mov_b32 v18, v146
    v_mov_b32 v19, v147
    buffer_store_dwordx4 v[16:19], v12, s[40:43], s44 offen sc1
F_se0:
    s_waitcnt lgkmcnt(10)
    v_mfma_f32_16x16x32_bf16 v[52:55], a[24:27], a[36:39], v[52:55]
    ds_read_b64_tr_b16 a[16:17], v8 offset:7264
    v_mfma_f32_16x16x32_bf16 v[56:59], a[24:27], a[40:43], v[56:59]
    ds_read_b64_tr_b16 a[18:19], v8 offset:10848
    v_mfma_f32_16x16x32_bf16 v[60:63], a[28:31], a[36:39], v[60:63]
    ds_read_b64_tr_b16 a[20:21], v7 offset:128
    v_mfma_f32_16x16x32_bf16 v[64:67], a[28:31], a[40:43], v[64:67]
    ds_read_b64_tr_b16 a[22:23], v7 offset:3712
    s_waitcnt lgkmcnt(10)
    v_mfma_f32_16x16x32_bf16 v[52:55], a[32:35], a[52:55], v[52:55]
    ds_read_b64_tr_b16 a[24:25], v7 offset:7296
    v_mfma_f32_16x16x32_bf16 v[56:59], a[32:35], a[56:59], v[56:59]
    ds_read_b64_tr_b16 a[26:27], v7 offset:10880
    v_mfma_f32_16x16x32_bf16 v[60:63], a[0:3], a[52:55], v[60:63]
    ds_read_b64_tr_b16 a[28:29], v8 offset:128
    v_mfma_f32_16x16x32_bf16 v[64:67], a[0:3], a[56:59], v[64:67]
    ds_read_b64_tr_b16 a[30:31], v8 offset:3712
    v_max_f32 v36, 0, v36
    v_max_f32 v37, 0, v37
    v_max_f32 v38, 0, v38
    v_max_f32 v39, 0, v39
    v_pk_mul_f32 v[36:37], v[36:37], v[44:45]
    v_pk_mul_f32 v[38:39], v[38:39], v[46:47]
    v_cvt_pk_bf16_f32 v134, v36, v37
    v_cvt_pk_bf16_f32 v135, v38, v39
    v_max_f32 v40, 0, v40
    v_max_f32 v41, 0, v41
    v_max_f32 v42, 0, v42
    v_max_f32 v43, 0, v43
    v_pk_mul_f32 v[40:41], v[40:41], v[48:49]
    v_pk_mul_f32 v[42:43], v[42:43], v[50:51]
    v_cvt_pk_bf16_f32 v148, v40, v41
    v_cvt_pk_bf16_f32 v149, v42, v43
    s_bitcmp1_b32 s20, 0
    s_cbranch_scc1 F_se1
    buffer_store_dwordx4 v[132:135], v12, s[28:31], s32 offen offset:0 sc1
    buffer_store_dwordx4 v[146:149], v12, s[28:31], s33 offen offset:0 sc1
F_se1:
    s_waitcnt lgkmcnt(10)
    v_mfma_f32_16x16x32_bf16 v[68:71], a[4:7], a[36:39], v[68:71]
    ds_read_b64_tr_b16 a[32:33], v8 offset:7296
    v_mfma_f32_16x16x32_bf16 v[72:75], a[4:7], a[40:43], v[72:75]
    ds_read_b64_tr_b16 a[34:35], v8 offset:10880
    v_mfma_f32_16x16x32_bf16 v[76:79], a[8:11], a[36:39], v[76:79]
    ds_read_b64_tr_b16 a[0:1], v7 offset:160
    v_mfma_f32_16x16x32_bf16 v[80:83], a[8:11], a[40:43], v[80:83]
    ds_read_b64_tr_b16 a[2:3], v7 offset:3744
    s_waitcnt lgkmcnt(10)
    v_mfma_f32_16x16x32_bf16 v[68:71], a[12:15], a[52:55], v[68:71]
    ds_read_b64_tr_b16 a[4:5], v7 offset:7328
    v_mfma_f32_16x16x32_bf16 v[72:75], a[12:15], a[56:59], v[72:75]
    ds_read_b64_tr_b16 a[6:7], v7 offset:10912
    v_mfma_f32_16x16x32_bf16 v[76:79], a[16:19], a[52:55], v[76:79]
    ds_read_b64_tr_b16 a[8:9], v8 offset:160
    v_mfma_f32_16x16x32_bf16 v[80:83], a[16:19], a[56:59], v[80:83]
    ds_read_b64_tr_b16 a[10:11], v8 offset:3744
    v_max_f32 v52, 0, v52
    v_max_f32 v53, 0, v53
    v_max_f32 v54, 0, v54
    v_max_f32 v55, 0, v55
    v_pk_mul_f32 v[52:53], v[52:53], v[60:61]
    v_pk_mul_f32 v[54:55], v[54:55], v[62:63]
    v_cvt_pk_bf16_f32 v136, v52, v53
    v_cvt_pk_bf16_f32 v137, v54, v55
    v_max_f32 v56, 0, v56
    v_max_f32 v57, 0, v57
    v_max_f32 v58, 0, v58
    v_max_f32 v59, 0, v59
    v_pk_mul_f32 v[56:57], v[56:57], v[64:65]
    v_pk_mul_f32 v[58:59], v[58:59], v[66:67]
    v_cvt_pk_bf16_f32 v150, v56, v57
    v_cvt_pk_bf16_f32 v151, v58, v59
    s_bitcmp1_b32 s20, 0
    s_cbranch_scc0 F_se2
    buffer_store_dwordx4 v[134:137], v12, s[28:31], s32 offen offset:1024 sc1
    buffer_store_dwordx4 v[148:151], v12, s[28:31], s33 offen offset:1024 sc1
F_se2:
    s_waitcnt lgkmcnt(10)
    v_mfma_f32_16x16x32_bf16 v[84:87], a[20:23], a[36:39], v[84:87]
    ds_read_b64_tr_b16 a[12:13], v8 offset:7328
    v_mfma_f32_16x16x32_bf16 v[88:91], a[20:23], a[40:43], v[88:91]
    ds_read_b64_tr_b16 a[14:15], v8 offset:10912
    v_mfma_f32_16x16x32_bf16 v[92:95], a[24:27], a[36:39], v[92:95]
    ds_read_b64_tr_b16 a[16:17], v7 offset:192
    v_mfma_f32_16x16x32_bf16 v[96:99], a[24:27], a[40:43], v[96:99]
    ds_read_b64_tr_b16 a[18:19], v7 offset:3776
    s_waitcnt lgkmcnt(10)
    v_mfma_f32_16x16x32_bf16 v[84:87], a[28:31], a[52:55], v[84:87]
    ds_read_b64_tr_b16 a[20:21], v7 offset:7360
    v_mfma_f32_16x16x32_bf16 v[88:91], a[28:31], a[56:59], v[88:91]
    ds_read_b64_tr_b16 a[22:23], v7 offset:10944
    v_mfma_f32_16x16x32_bf16 v[92:95], a[32:35], a[52:55], v[92:95]
    ds_read_b64_tr_b16 a[24:25], v8 offset:192
    v_mfma_f32_16x16x32_bf16 v[96:99], a[32:35], a[56:59], v[96:99]
    ds_read_b64_tr_b16 a[26:27], v8 offset:3776
    v_max_f32 v68, 0, v68
    v_max_f32 v69, 0, v69
    v_max_f32 v70, 0, v70
    v_max_f32 v71, 0, v71
    v_pk_mul_f32 v[68:69], v[68:69], v[76:77]
    v_pk_mul_f32 v[70:71], v[70:71], v[78:79]
    v_cvt_pk_bf16_f32 v138, v68, v69
    v_cvt_pk_bf16_f32 v139, v70, v71
    v_max_f32 v72, 0, v72
    v_max_f32 v73, 0, v73
    v_max_f32 v74, 0, v74
    v_max_f32 v75, 0, v75
    v_pk_mul_f32 v[72:73], v[72:73], v[80:81]
    v_pk_mul_f32 v[74:75], v[74:75], v[82:83]
    v_cvt_pk_bf16_f32 v152, v72, v73
    v_cvt_pk_bf16_f32 v153, v74, v75
    s_bitcmp1_b32 s20, 0
    s_cbranch_scc1 F_se3
    buffer_store_dwordx4 v[136:139], v12, s[28:31], s32 offen offset:1024 sc1
    buffer_store_dwordx4 v[150:153], v12, s[28:31], s33 offen offset:1024 sc1
F_se3:
    s_waitcnt lgkmcnt(10)
    v_mfma_f32_16x16x32_bf16 v[100:103], a[0:3], a[36:39], v[100:103]
    ds_read_b64_tr_b16 a[28:29], v8 offset:7360
    v_mfma_f32_16x16x32_bf16 v[104:107], a[0:3], a[40:43], v[104:107]
    ds_read_b64_tr_b16 a[30:31], v8 offset:10944
    v_mfma_f32_16x16x32_bf16 v[108:111], a[4:7], a[36:39], v[108:111]
    v_mfma_f32_16x16x32_bf16 v[112:115], a[4:7], a[40:43], v[112:115]
    s_waitcnt lgkmcnt(8)
    v_mfma_f32_16x16x32_bf16 v[100:103], a[8:11], a[52:55], v[100:103]
    v_mfma_f32_16x16x32_bf16 v[104:107], a[8:11], a[56:59], v[104:107]
    v_mfma_f32_16x16x32_bf16 v[108:111], a[12:15], a[52:55], v[108:111]
    v_mfma_f32_16x16x32_bf16 v[112:115], a[12:15], a[56:59], v[112:115]
    v_max_f32 v84, 0, v84
    v_max_f32 v85, 0, v85
    v_max_f32 v86, 0, v86
    v_max_f32 v87, 0, v87
    v_pk_mul_f32 v[84:85], v[84:85], v[92:93]
    v_pk_mul_f32 v[86:87], v[86:87], v[94:95]
    v_cvt_pk_bf16_f32 v140, v84, v85
    v_cvt_pk_bf16_f32 v141, v86, v87
    v_max_f32 v88, 0, v88
    v_max_f32 v89, 0, v89
    v_max_f32 v90, 0, v90
    v_max_f32 v91, 0, v91
    v_pk_mul_f32 v[88:89], v[88:89], v[96:97]
    v_pk_mul_f32 v[90:91], v[90:91], v[98:99]
    v_cvt_pk_bf16_f32 v154, v88, v89
    v_cvt_pk_bf16_f32 v155, v90, v91
    s_bitcmp1_b32 s20, 0
    s_cbranch_scc0 F_se4
    buffer_store_dwordx4 v[138:141], v12, s[28:31], s32 offen offset:2048 sc1
    buffer_store_dwordx4 v[152:155], v12, s[28:31], s33 offen offset:2048 sc1
F_se4:
    s_waitcnt lgkmcnt(4)
    v_mfma_f32_16x16x32_bf16 v[116:119], a[16:19], a[36:39], v[116:119]
    v_mfma_f32_16x16x32_bf16 v[120:123], a[16:19], a[40:43], v[120:123]
    v_mfma_f32_16x16x32_bf16 v[124:127], a[20:23], a[36:39], v[124:127]
    v_mfma_f32_16x16x32_bf16 v[128:131], a[20:23], a[40:43], v[128:131]
    s_waitcnt lgkmcnt(0)
    v_mfma_f32_16x16x32_bf16 v[116:119], a[24:27], a[52:55], v[116:119]
    v_mfma_f32_16x16x32_bf16 v[120:123], a[24:27], a[56:59], v[120:123]
    v_mfma_f32_16x16x32_bf16 v[124:127], a[28:31], a[52:55], v[124:127]
    v_mfma_f32_16x16x32_bf16 v[128:131], a[28:31], a[56:59], v[128:131]
    v_max_f32 v100, 0, v100
    v_max_f32 v101, 0, v101
    v_max_f32 v102, 0, v102
    v_max_f32 v103, 0, v103
    v_pk_mul_f32 v[100:101], v[100:101], v[108:109]
    v_pk_mul_f32 v[102:103], v[102:103], v[110:111]
    v_cvt_pk_bf16_f32 v142, v100, v101
    v_cvt_pk_bf16_f32 v143, v102, v103
    v_max_f32 v104, 0, v104
    v_max_f32 v105, 0, v105
    v_max_f32 v106, 0, v106
    v_max_f32 v107, 0, v107
    v_pk_mul_f32 v[104:105], v[104:105], v[112:113]
    v_pk_mul_f32 v[106:107], v[106:107], v[114:115]
    v_cvt_pk_bf16_f32 v156, v104, v105
    v_cvt_pk_bf16_f32 v157, v106, v107
    s_bitcmp1_b32 s20, 0
    s_cbranch_scc1 F_se5
    buffer_store_dwordx4 v[140:143], v12, s[28:31], s32 offen offset:2048 sc1
    buffer_store_dwordx4 v[154:157], v12, s[28:31], s33 offen offset:2048 sc1
F_se5:
    v_max_f32 v116, 0, v116
    v_max_f32 v117, 0, v117
    v_max_f32 v118, 0, v118
    v_max_f32 v119, 0, v119
    v_pk_mul_f32 v[116:117], v[116:117], v[124:125]
    v_pk_mul_f32 v[118:119], v[118:119], v[126:127]
    v_cvt_pk_bf16_f32 v144, v116, v117
    v_cvt_pk_bf16_f32 v145, v118, v119
    v_max_f32 v120, 0, v120
    v_max_f32 v121, 0, v121
    v_max_f32 v122, 0, v122
    v_max_f32 v123, 0, v123
    v_pk_mul_f32 v[120:121], v[120:121], v[128:129]
    v_pk_mul_f32 v[122:123], v[122:123], v[130:131]
    v_cvt_pk_bf16_f32 v158, v120, v121
    v_cvt_pk_bf16_f32 v159, v122, v123
    s_bitcmp1_b32 s20, 0
    s_cbranch_scc1 F_so6
    v_mov_b32 v16, v144
    v_mov_b32 v17, v145
    v_mov_b32 v18, v158
    v_mov_b32 v19, v159
    buffer_store_dwordx4 v[16:19], v12, s[40:43], s44 offen sc1
    s_branch F_se6
F_so6:
    buffer_store_dwordx4 v[142:145], v12, s[28:31], s32 offen offset:3072 sc1
    buffer_store_dwordx4 v[156:159], v12, s[28:31], s33 offen offset:3072 sc1
F_se6:
    s_waitcnt vmcnt(0)
    s_barrier
    s_cmp_lg_u32 s16, 0
    s_cbranch_scc1 F_w2
    s_mov_b64 s[34:35], exec
    s_mov_b64 exec, 0xffff
    s_lshl_b32 s17, s19, 11
    s_lshl_b32 s18, s20, 2
    s_add_u32 s17, s17, s18
    s_add_u32 s17, s17, 32768
    v_lshlrev_b32 v4, 7, v3
    v_add_u32 v4, s17, v4
    v_mov_b32 v5, 1
    global_store_dword v4, v5, s[24:25] sc1
    s_lshl_b32 s17, s21, 3
    s_add_u32 s17, s17, s22
    s_lshl_b32 s17, s17, 7
    s_add_u32 s17, s17, 32768
    v_lshlrev_b32 v4, 2, v3
    v_add_u32 v4, s17, v4
    s_mov_b32 s36, 0
F_p2_poll:
    global_load_dword v5, v4, s[24:25] sc1
    s_add_u32 s36, s36, 1
    s_waitcnt vmcnt(0)
    v_cmp_eq_u32 vcc, 0, v5
    s_cmp_gt_u32 s36, 100000
    s_cbranch_scc1 F_p2_out
    s_cbranch_vccz F_p2_out
    s_sleep 2
    s_branch F_p2_poll
F_p2_out:
    s_mov_b64 exec, s[34:35]
F_w2:
    s_and_b32 s49, s16, 1
    s_lshr_b32 s50, s16, 1
    s_lshl_b32 s17, s21, 2
    s_lshl_b32 s18, s49, 1
    s_add_u32 s17, s17, s18
    s_mul_i32 s44, s17, 57344
    s_mul_i32 s18, s50, 28672
    s_add_u32 s44, s44, s18
    s_add_u32 s45, s44, 57344
    s_lshr_b32 s18, s17, 1
    s_lshl_b32 s51, s18, 14
    s_lshl_b32 s18, s50, 13
    s_add_u32 s51, s51, s18
    s_add_u32 s17, s17, s50
    s_lshl_b32 s48, s17, 14
    s_lshl_b32 s17, s22, 7
    s_add_u32 s48, s48, s17
    v_lshlrev_b32 v6, 4, v3
    v_bfe_u32 v4, v3, 2, 2
    v_lshl_add_u32 v20, v2, 2, v4
    v_bfe_u32 v21, v20, 1, 2
    v_lshlrev_b32 v21, 1, v21
    v_and_b32 v4, 3, v3
    v_lshrrev_b32 v5, 1, v4
    v_and_b32 v4, 1, v4
    v_lshlrev_b32 v4, 3, v4
    v_lshl_add_u32 v4, v5, 4, v4
    v_lshl_add_u32 v4, v20, 7, v4
    s_lshl_b32 s17, s50, 13
    v_add_u32 v4, s17, v4
    v_xor_b32 v5, 0, v21
    v_lshl_add_u32 v8, v5, 4, v4
    v_xor_b32 v5, 2, v21
    v_lshl_add_u32 v9, v5, 4, v4
    v_xor_b32 v5, 4, v21
    v_lshl_add_u32 v10, v5, 4, v4
    v_xor_b32 v5, 6, v21
    v_lshl_add_u32 v11, v5, 4, v4
    v_lshlrev_b32 v7, 10, v1
    v_and_b32 v4, 1, v2
    v_lshl_add_u32 v7, v4, 5, v7
    v_lshrrev_b32 v4, 1, v2
    v_lshl_add_u32 v7, v4, 4, v7
    s_lshl_b32 s17, s16, 12
    s_add_u32 s17, s17, 49152
    v_add_u32 v22, s17, v6
    s_xor_b32 s18, s16, 2
    s_lshl_b32 s18, s18, 12
    s_add_u32 s18, s18, 49152
    v_add_u32 v23, s18, v6
    s_mov_b32 s28, s6
    s_mov_b32 s29, s7
    s_and_b32 s29, s29, 0xffff
    s_mov_b32 s30, 0x700000
    s_mov_b32 s31, 0x20000
    s_add_u32 s32, s6, 0xa00000
    s_addc_u32 s33, s7, 0
    s_and_b32 s33, s33, 0xffff
    s_mov_b32 s34, 0x200000
    s_mov_b32 s35, 0x20000
    s_mov_b32 s36, s14
    s_mov_b32 s37, s15
    s_and_b32 s37, s37, 0xffff
    s_mov_b32 s38, 0x200000
    s_mov_b32 s39, 0x20000
    s_add_u32 s40, s6, 0x1300000
    s_addc_u32 s41, s7, 0
    s_and_b32 s41, s41, 0xffff
    s_mov_b32 s42, 0x100000
    s_mov_b32 s43, 0x20000
    s_barrier
    s_add_u32 s46, s44, 0
    s_add_u32 s47, s45, 0
    buffer_load_dwordx4 v[24:27], v6, s[28:31], s46 offen offset:0 sc1
    buffer_load_dwordx4 v[28:31], v6, s[28:31], s47 offen offset:0 sc1
    buffer_load_dwordx4 v[32:35], v6, s[28:31], s46 offen offset:1024 sc1
    buffer_load_dwordx4 v[36:39], v6, s[28:31], s47 offen offset:1024 sc1
    buffer_load_dwordx4 v[40:43], v6, s[28:31], s46 offen offset:2048 sc1
    buffer_load_dwordx4 v[44:47], v6, s[28:31], s47 offen offset:2048 sc1
    s_barrier
    v_add_u32 v12, 49152, v8
    v_add_u32 v13, 49152, v9
    v_add_u32 v14, 49152, v10
    v_add_u32 v15, 49152, v11
    ds_read_b64_tr_b16 v[120:121], v12 offset:0
    ds_read_b64_tr_b16 v[122:123], v12 offset:2048
    ds_read_b64_tr_b16 v[124:125], v13 offset:0
    ds_read_b64_tr_b16 v[126:127], v13 offset:2048
    ds_read_b64_tr_b16 v[128:129], v14 offset:0
    ds_read_b64_tr_b16 v[130:131], v14 offset:2048
    ds_read_b64_tr_b16 v[132:133], v15 offset:0
    ds_read_b64_tr_b16 v[134:135], v15 offset:2048
    ds_read_b64_tr_b16 v[136:137], v12 offset:4096
    ds_read_b64_tr_b16 v[138:139], v12 offset:6144
    ds_read_b64_tr_b16 v[140:141], v13 offset:4096
    ds_read_b64_tr_b16 v[142:143], v13 offset:6144
    ds_read_b64_tr_b16 v[144:145], v14 offset:4096
    ds_read_b64_tr_b16 v[146:147], v14 offset:6144
    s_waitcnt vmcnt(4)
    s_waitcnt lgkmcnt(10)
    v_mfma_f32_16x16x32_bf16 v[88:91], v[120:123], v[24:27], 0
    ds_read_b64_tr_b16 v[148:149], v15 offset:4096
    v_mfma_f32_16x16x32_bf16 v[104:107], v[120:123], v[28:31], 0
    ds_read_b64_tr_b16 v[150:151], v15 offset:6144
    v_add_u32 v16, 65536, v8
    v_add_u32 v17, 65536, v9
    v_add_u32 v18, 65536, v10
    v_add_u32 v19, 65536, v11
    v_mfma_f32_16x16x32_bf16 v[92:95], v[124:127], v[24:27], 0
    ds_read_b64_tr_b16 v[152:153], v16 offset:0
    v_mfma_f32_16x16x32_bf16 v[108:111], v[124:127], v[28:31], 0
    ds_read_b64_tr_b16 v[154:155], v16 offset:2048
    s_add_u32 s52, s51, 0
    buffer_load_dwordx2 v[48:49], v6, s[40:43], s52 offen offset:0 sc1
    buffer_load_dwordx2 v[50:51], v6, s[40:43], s52 offen offset:1024 sc1
    buffer_load_dwordx2 v[52:53], v6, s[40:43], s52 offen offset:8 sc1
    buffer_load_dwordx2 v[54:55], v6, s[40:43], s52 offen offset:1032 sc1
    s_waitcnt lgkmcnt(10)
    v_mfma_f32_16x16x32_bf16 v[96:99], v[128:131], v[24:27], 0
    ds_read_b64_tr_b16 v[120:121], v17 offset:0
    v_mfma_f32_16x16x32_bf16 v[112:115], v[128:131], v[28:31], 0
    ds_read_b64_tr_b16 v[122:123], v17 offset:2048
    v_mfma_f32_16x16x32_bf16 v[100:103], v[132:135], v[24:27], 0
    ds_read_b64_tr_b16 v[124:125], v18 offset:0
    v_mfma_f32_16x16x32_bf16 v[116:119], v[132:135], v[28:31], 0
    ds_read_b64_tr_b16 v[126:127], v18 offset:2048
    s_add_u32 s46, s44, 4096
    s_add_u32 s47, s45, 4096
    buffer_load_dwordx4 v[56:59], v6, s[28:31], s46 offen offset:0 sc1
    buffer_load_dwordx4 v[60:63], v6, s[28:31], s47 offen offset:0 sc1
    s_waitcnt vmcnt(8)
    s_waitcnt lgkmcnt(10)
    v_mfma_f32_16x16x32_bf16 v[88:91], v[136:139], v[32:35], v[88:91]
    ds_read_b64_tr_b16 v[128:129], v19 offset:0
    v_mfma_f32_16x16x32_bf16 v[104:107], v[136:139], v[36:39], v[104:107]
    ds_read_b64_tr_b16 v[130:131], v19 offset:2048
    v_mfma_f32_16x16x32_bf16 v[92:95], v[140:143], v[32:35], v[92:95]
    ds_read_b64_tr_b16 v[132:133], v16 offset:4096
    v_mfma_f32_16x16x32_bf16 v[108:111], v[140:143], v[36:39], v[108:111]
    ds_read_b64_tr_b16 v[134:135], v16 offset:6144
    buffer_load_dwordx4 v[64:67], v6, s[28:31], s46 offen offset:1024 sc1
    buffer_load_dwordx4 v[68:71], v6, s[28:31], s47 offen offset:1024 sc1
    s_waitcnt lgkmcnt(10)
    v_mfma_f32_16x16x32_bf16 v[96:99], v[144:147], v[32:35], v[96:99]
    ds_read_b64_tr_b16 v[136:137], v17 offset:4096
    v_mfma_f32_16x16x32_bf16 v[112:115], v[144:147], v[36:39], v[112:115]
    ds_read_b64_tr_b16 v[138:139], v17 offset:6144
    v_mfma_f32_16x16x32_bf16 v[100:103], v[148:151], v[32:35], v[100:103]
    ds_read_b64_tr_b16 v[140:141], v18 offset:4096
    v_mfma_f32_16x16x32_bf16 v[116:119], v[148:151], v[36:39], v[116:119]
    ds_read_b64_tr_b16 v[142:143], v18 offset:6144
    buffer_load_dwordx4 v[72:75], v6, s[28:31], s46 offen offset:2048 sc1
    buffer_load_dwordx4 v[76:79], v6, s[28:31], s47 offen offset:2048 sc1
    s_waitcnt vmcnt(10)
    s_waitcnt lgkmcnt(10)
    v_mfma_f32_16x16x32_bf16 v[88:91], v[152:155], v[40:43], v[88:91]
    ds_read_b64_tr_b16 v[144:145], v19 offset:4096
    v_mfma_f32_16x16x32_bf16 v[104:107], v[152:155], v[44:47], v[104:107]
    ds_read_b64_tr_b16 v[146:147], v19 offset:6144
    v_add_u32 v12, 81920, v8
    v_add_u32 v13, 81920, v9
    v_add_u32 v14, 81920, v10
    v_add_u32 v15, 81920, v11
    v_mfma_f32_16x16x32_bf16 v[92:95], v[120:123], v[40:43], v[92:95]
    ds_read_b64_tr_b16 v[148:149], v12 offset:0
    v_mfma_f32_16x16x32_bf16 v[108:111], v[120:123], v[44:47], v[108:111]
    ds_read_b64_tr_b16 v[150:151], v12 offset:2048
    buffer_load_dwordx4 v[80:83], v6, s[28:31], s46 offen offset:3072 sc1
    buffer_load_dwordx4 v[84:87], v6, s[28:31], s47 offen offset:3072 sc1
    s_waitcnt lgkmcnt(10)
    v_mfma_f32_16x16x32_bf16 v[96:99], v[124:127], v[40:43], v[96:99]
    ds_read_b64_tr_b16 v[152:153], v13 offset:0
    v_mfma_f32_16x16x32_bf16 v[112:115], v[124:127], v[44:47], v[112:115]
    ds_read_b64_tr_b16 v[154:155], v13 offset:2048
    v_mfma_f32_16x16x32_bf16 v[100:103], v[128:131], v[40:43], v[100:103]
    ds_read_b64_tr_b16 v[120:121], v14 offset:0
    v_mfma_f32_16x16x32_bf16 v[116:119], v[128:131], v[44:47], v[116:119]
    ds_read_b64_tr_b16 v[122:123], v14 offset:2048
    s_add_u32 s46, s44, 8192
    s_add_u32 s47, s45, 8192
    buffer_load_dwordx4 v[24:27], v6, s[28:31], s46 offen offset:0 sc1
    buffer_load_dwordx4 v[28:31], v6, s[28:31], s47 offen offset:0 sc1
    s_waitcnt vmcnt(10)
    s_waitcnt lgkmcnt(10)
    v_mfma_f32_16x16x32_bf16 v[88:91], v[132:135], v[48:51], v[88:91]
    ds_read_b64_tr_b16 v[124:125], v15 offset:0
    v_mfma_f32_16x16x32_bf16 v[104:107], v[132:135], v[52:55], v[104:107]
    ds_read_b64_tr_b16 v[126:127], v15 offset:2048
    v_mfma_f32_16x16x32_bf16 v[92:95], v[136:139], v[48:51], v[92:95]
    ds_read_b64_tr_b16 v[128:129], v12 offset:4096
    v_mfma_f32_16x16x32_bf16 v[108:111], v[136:139], v[52:55], v[108:111]
    ds_read_b64_tr_b16 v[130:131], v12 offset:6144
    s_waitcnt lgkmcnt(10)
    v_mfma_f32_16x16x32_bf16 v[96:99], v[140:143], v[48:51], v[96:99]
    ds_read_b64_tr_b16 v[132:133], v13 offset:4096
    v_mfma_f32_16x16x32_bf16 v[112:115], v[140:143], v[52:55], v[112:115]
    ds_read_b64_tr_b16 v[134:135], v13 offset:6144
    v_mfma_f32_16x16x32_bf16 v[100:103], v[144:147], v[48:51], v[100:103]
    ds_read_b64_tr_b16 v[136:137], v14 offset:4096
    v_mfma_f32_16x16x32_bf16 v[116:119], v[144:147], v[52:55], v[116:119]
    ds_read_b64_tr_b16 v[138:139], v14 offset:6144
    buffer_load_dwordx4 v[32:35], v6, s[28:31], s46 offen offset:1024 sc1
    buffer_load_dwordx4 v[36:39], v6, s[28:31], s47 offen offset:1024 sc1
    s_waitcnt vmcnt(10)
    s_waitcnt lgkmcnt(10)
    v_mfma_f32_16x16x32_bf16 v[88:91], v[148:151], v[56:59], v[88:91]
    ds_read_b64_tr_b16 v[140:141], v15 offset:4096
    v_mfma_f32_16x16x32_bf16 v[104:107], v[148:151], v[60:63], v[104:107]
    ds_read_b64_tr_b16 v[142:143], v15 offset:6144
    v_add_u32 v16, 98304, v8
    v_add_u32 v17, 98304, v9
    v_add_u32 v18, 98304, v10
    v_add_u32 v19, 98304, v11
    v_mfma_f32_16x16x32_bf16 v[92:95], v[152:155], v[56:59], v[92:95]
    ds_read_b64_tr_b16 v[144:145], v16 offset:0
    v_mfma_f32_16x16x32_bf16 v[108:111], v[152:155], v[60:63], v[108:111]
    ds_read_b64_tr_b16 v[146:147], v16 offset:2048
    s_waitcnt lgkmcnt(10)
    v_mfma_f32_16x16x32_bf16 v[96:99], v[120:123], v[56:59], v[96:99]
    ds_read_b64_tr_b16 v[148:149], v17 offset:0
    v_mfma_f32_16x16x32_bf16 v[112:115], v[120:123], v[60:63], v[112:115]
    ds_read_b64_tr_b16 v[150:151], v17 offset:2048
    v_mfma_f32_16x16x32_bf16 v[100:103], v[124:127], v[56:59], v[100:103]
    ds_read_b64_tr_b16 v[152:153], v18 offset:0
    v_mfma_f32_16x16x32_bf16 v[116:119], v[124:127], v[60:63], v[116:119]
    ds_read_b64_tr_b16 v[154:155], v18 offset:2048
    s_add_u32 s52, s51, 2048
    buffer_load_dwordx2 v[40:41], v6, s[40:43], s52 offen offset:0 sc1
    buffer_load_dwordx2 v[42:43], v6, s[40:43], s52 offen offset:1024 sc1
    buffer_load_dwordx2 v[44:45], v6, s[40:43], s52 offen offset:8 sc1
    buffer_load_dwordx2 v[46:47], v6, s[40:43], s52 offen offset:1032 sc1
    s_waitcnt vmcnt(12)
    s_waitcnt lgkmcnt(10)
    v_mfma_f32_16x16x32_bf16 v[88:91], v[128:131], v[64:67], v[88:91]
    ds_read_b64_tr_b16 v[120:121], v19 offset:0
    v_mfma_f32_16x16x32_bf16 v[104:107], v[128:131], v[68:71], v[104:107]
    ds_read_b64_tr_b16 v[122:123], v19 offset:2048
    v_mfma_f32_16x16x32_bf16 v[92:95], v[132:135], v[64:67], v[92:95]
    ds_read_b64_tr_b16 v[124:125], v16 offset:4096
    v_mfma_f32_16x16x32_bf16 v[108:111], v[132:135], v[68:71], v[108:111]
    ds_read_b64_tr_b16 v[126:127], v16 offset:6144
    s_waitcnt lgkmcnt(10)
    v_mfma_f32_16x16x32_bf16 v[96:99], v[136:139], v[64:67], v[96:99]
    ds_read_b64_tr_b16 v[128:129], v17 offset:4096
    v_mfma_f32_16x16x32_bf16 v[112:115], v[136:139], v[68:71], v[112:115]
    ds_read_b64_tr_b16 v[130:131], v17 offset:6144
    v_mfma_f32_16x16x32_bf16 v[100:103], v[140:143], v[64:67], v[100:103]
    ds_read_b64_tr_b16 v[132:133], v18 offset:4096
    v_mfma_f32_16x16x32_bf16 v[116:119], v[140:143], v[68:71], v[116:119]
    ds_read_b64_tr_b16 v[134:135], v18 offset:6144
    buffer_load_dwordx4 v[48:51], v6, s[28:31], s46 offen offset:3072 sc1
    buffer_load_dwordx4 v[52:55], v6, s[28:31], s47 offen offset:3072 sc1
    s_waitcnt vmcnt(12)
    s_waitcnt lgkmcnt(10)
    v_mfma_f32_16x16x32_bf16 v[88:91], v[144:147], v[72:75], v[88:91]
    ds_read_b64_tr_b16 v[136:137], v19 offset:4096
    v_mfma_f32_16x16x32_bf16 v[104:107], v[144:147], v[76:79], v[104:107]
    ds_read_b64_tr_b16 v[138:139], v19 offset:6144
    v_add_u32 v12, 114688, v8
    v_add_u32 v13, 114688, v9
    v_add_u32 v14, 114688, v10
    v_add_u32 v15, 114688, v11
    v_mfma_f32_16x16x32_bf16 v[92:95], v[148:151], v[72:75], v[92:95]
    ds_read_b64_tr_b16 v[140:141], v12 offset:0
    v_mfma_f32_16x16x32_bf16 v[108:111], v[148:151], v[76:79], v[108:111]
    ds_read_b64_tr_b16 v[142:143], v12 offset:2048
    s_waitcnt lgkmcnt(10)
    v_mfma_f32_16x16x32_bf16 v[96:99], v[152:155], v[72:75], v[96:99]
    ds_read_b64_tr_b16 v[144:145], v13 offset:0
    v_mfma_f32_16x16x32_bf16 v[112:115], v[152:155], v[76:79], v[112:115]
    ds_read_b64_tr_b16 v[146:147], v13 offset:2048
    v_mfma_f32_16x16x32_bf16 v[100:103], v[120:123], v[72:75], v[100:103]
    ds_read_b64_tr_b16 v[148:149], v14 offset:0
    v_mfma_f32_16x16x32_bf16 v[116:119], v[120:123], v[76:79], v[116:119]
    ds_read_b64_tr_b16 v[150:151], v14 offset:2048
    s_add_u32 s46, s44, 12288
    s_add_u32 s47, s45, 12288
    buffer_load_dwordx4 v[56:59], v6, s[28:31], s46 offen offset:0 sc1
    buffer_load_dwordx4 v[60:63], v6, s[28:31], s47 offen offset:0 sc1
    s_waitcnt vmcnt(12)
    s_waitcnt lgkmcnt(10)
    v_mfma_f32_16x16x32_bf16 v[88:91], v[124:127], v[80:83], v[88:91]
    ds_read_b64_tr_b16 v[152:153], v15 offset:0
    v_mfma_f32_16x16x32_bf16 v[104:107], v[124:127], v[84:87], v[104:107]
    ds_read_b64_tr_b16 v[154:155], v15 offset:2048
    v_mfma_f32_16x16x32_bf16 v[92:95], v[128:131], v[80:83], v[92:95]
    ds_read_b64_tr_b16 v[120:121], v12 offset:4096
    v_mfma_f32_16x16x32_bf16 v[108:111], v[128:131], v[84:87], v[108:111]
    ds_read_b64_tr_b16 v[122:123], v12 offset:6144
    s_waitcnt lgkmcnt(10)
    v_mfma_f32_16x16x32_bf16 v[96:99], v[132:135], v[80:83], v[96:99]
    ds_read_b64_tr_b16 v[124:125], v13 offset:4096
    v_mfma_f32_16x16x32_bf16 v[112:115], v[132:135], v[84:87], v[112:115]
    ds_read_b64_tr_b16 v[126:127], v13 offset:6144
    v_mfma_f32_16x16x32_bf16 v[100:103], v[136:139], v[80:83], v[100:103]
    ds_read_b64_tr_b16 v[128:129], v14 offset:4096
    v_mfma_f32_16x16x32_bf16 v[116:119], v[136:139], v[84:87], v[116:119]
    ds_read_b64_tr_b16 v[130:131], v14 offset:6144
    buffer_load_dwordx4 v[64:67], v6, s[28:31], s46 offen offset:1024 sc1
    buffer_load_dwordx4 v[68:71], v6, s[28:31], s47 offen offset:1024 sc1
    s_waitcnt vmcnt(12)
    s_waitcnt lgkmcnt(10)
    v_mfma_f32_16x16x32_bf16 v[88:91], v[140:143], v[24:27], v[88:91]
    ds_read_b64_tr_b16 v[132:133], v15 offset:4096
    v_mfma_f32_16x16x32_bf16 v[104:107], v[140:143], v[28:31], v[104:107]
    ds_read_b64_tr_b16 v[134:135], v15 offset:6144
    v_add_u32 v16, 131072, v8
    v_add_u32 v17, 131072, v9
    v_add_u32 v18, 131072, v10
    v_add_u32 v19, 131072, v11
    v_mfma_f32_16x16x32_bf16 v[92:95], v[144:147], v[24:27], v[92:95]
    ds_read_b64_tr_b16 v[136:137], v16 offset:0
    v_mfma_f32_16x16x32_bf16 v[108:111], v[144:147], v[28:31], v[108:111]
    ds_read_b64_tr_b16 v[138:139], v16 offset:2048
    s_waitcnt lgkmcnt(10)
    v_mfma_f32_16x16x32_bf16 v[96:99], v[148:151], v[24:27], v[96:99]
    ds_read_b64_tr_b16 v[140:141], v17 offset:0
    v_mfma_f32_16x16x32_bf16 v[112:115], v[148:151], v[28:31], v[112:115]
    ds_read_b64_tr_b16 v[142:143], v17 offset:2048
    v_mfma_f32_16x16x32_bf16 v[100:103], v[152:155], v[24:27], v[100:103]
    ds_read_b64_tr_b16 v[144:145], v18 offset:0
    v_mfma_f32_16x16x32_bf16 v[116:119], v[152:155], v[28:31], v[116:119]
    ds_read_b64_tr_b16 v[146:147], v18 offset:2048
    buffer_load_dwordx4 v[72:75], v6, s[28:31], s46 offen offset:2048 sc1
    buffer_load_dwordx4 v[76:79], v6, s[28:31], s47 offen offset:2048 sc1
    s_waitcnt vmcnt(12)
    s_waitcnt lgkmcnt(10)
    v_mfma_f32_16x16x32_bf16 v[88:91], v[120:123], v[32:35], v[88:91]
    ds_read_b64_tr_b16 v[148:149], v19 offset:0
    v_mfma_f32_16x16x32_bf16 v[104:107], v[120:123], v[36:39], v[104:107]
    ds_read_b64_tr_b16 v[150:151], v19 offset:2048
    v_mfma_f32_16x16x32_bf16 v[92:95], v[124:127], v[32:35], v[92:95]
    ds_read_b64_tr_b16 v[152:153], v16 offset:4096
    v_mfma_f32_16x16x32_bf16 v[108:111], v[124:127], v[36:39], v[108:111]
    ds_read_b64_tr_b16 v[154:155], v16 offset:6144
    s_waitcnt lgkmcnt(10)
    v_mfma_f32_16x16x32_bf16 v[96:99], v[128:131], v[32:35], v[96:99]
    ds_read_b64_tr_b16 v[120:121], v17 offset:4096
    v_mfma_f32_16x16x32_bf16 v[112:115], v[128:131], v[36:39], v[112:115]
    ds_read_b64_tr_b16 v[122:123], v17 offset:6144
    v_mfma_f32_16x16x32_bf16 v[100:103], v[132:135], v[32:35], v[100:103]
    ds_read_b64_tr_b16 v[124:125], v18 offset:4096
    v_mfma_f32_16x16x32_bf16 v[116:119], v[132:135], v[36:39], v[116:119]
    ds_read_b64_tr_b16 v[126:127], v18 offset:6144
    buffer_load_dwordx4 v[80:83], v6, s[28:31], s46 offen offset:3072 sc1
    buffer_load_dwordx4 v[84:87], v6, s[28:31], s47 offen offset:3072 sc1
    s_waitcnt vmcnt(10)
    s_waitcnt lgkmcnt(10)
    v_mfma_f32_16x16x32_bf16 v[88:91], v[136:139], v[40:43], v[88:91]
    ds_read_b64_tr_b16 v[128:129], v19 offset:4096
    v_mfma_f32_16x16x32_bf16 v[104:107], v[136:139], v[44:47], v[104:107]
    ds_read_b64_tr_b16 v[130:131], v19 offset:6144
    s_barrier
    v_add_u32 v12, 147456, v8
    v_add_u32 v13, 147456, v9
    v_add_u32 v14, 147456, v10
    v_add_u32 v15, 147456, v11
    v_mfma_f32_16x16x32_bf16 v[92:95], v[140:143], v[40:43], v[92:95]
    ds_read_b64_tr_b16 v[132:133], v12 offset:0
    v_mfma_f32_16x16x32_bf16 v[108:111], v[140:143], v[44:47], v[108:111]
    ds_read_b64_tr_b16 v[134:135], v12 offset:2048
    s_waitcnt lgkmcnt(10)
    v_mfma_f32_16x16x32_bf16 v[96:99], v[144:147], v[40:43], v[96:99]
    ds_read_b64_tr_b16 v[136:137], v13 offset:0
    v_mfma_f32_16x16x32_bf16 v[112:115], v[144:147], v[44:47], v[112:115]
    ds_read_b64_tr_b16 v[138:139], v13 offset:2048
    v_mfma_f32_16x16x32_bf16 v[100:103], v[148:151], v[40:43], v[100:103]
    ds_read_b64_tr_b16 v[140:141], v14 offset:0
    v_mfma_f32_16x16x32_bf16 v[116:119], v[148:151], v[44:47], v[116:119]
    ds_read_b64_tr_b16 v[142:143], v14 offset:2048
    s_add_u32 s46, s44, 16384
    s_add_u32 s47, s45, 16384
    buffer_load_dwordx4 v[24:27], v6, s[28:31], s46 offen offset:0 sc1
    buffer_load_dwordx4 v[28:31], v6, s[28:31], s47 offen offset:0 sc1
    s_waitcnt vmcnt(10)
    s_waitcnt lgkmcnt(10)
    v_mfma_f32_16x16x32_bf16 v[88:91], v[152:155], v[48:51], v[88:91]
    ds_read_b64_tr_b16 v[144:145], v15 offset:0
    v_mfma_f32_16x16x32_bf16 v[104:107], v[152:155], v[52:55], v[104:107]
    ds_read_b64_tr_b16 v[146:147], v15 offset:2048
    v_mfma_f32_16x16x32_bf16 v[92:95], v[120:123], v[48:51], v[92:95]
    ds_read_b64_tr_b16 v[148:149], v12 offset:4096
    v_mfma_f32_16x16x32_bf16 v[108:111], v[120:123], v[52:55], v[108:111]
    ds_read_b64_tr_b16 v[150:151], v12 offset:6144
    s_waitcnt lgkmcnt(10)
    v_mfma_f32_16x16x32_bf16 v[96:99], v[124:127], v[48:51], v[96:99]
    ds_read_b64_tr_b16 v[152:153], v13 offset:4096
    v_mfma_f32_16x16x32_bf16 v[112:115], v[124:127], v[52:55], v[112:115]
    ds_read_b64_tr_b16 v[154:155], v13 offset:6144
    v_mfma_f32_16x16x32_bf16 v[100:103], v[128:131], v[48:51], v[100:103]
    ds_read_b64_tr_b16 v[120:121], v14 offset:4096
    v_mfma_f32_16x16x32_bf16 v[116:119], v[128:131], v[52:55], v[116:119]
    ds_read_b64_tr_b16 v[122:123], v14 offset:6144
    s_add_u32 s52, s51, 4096
    buffer_load_dwordx2 v[32:33], v6, s[40:43], s52 offen offset:0 sc1
    buffer_load_dwordx2 v[34:35], v6, s[40:43], s52 offen offset:1024 sc1
    buffer_load_dwordx2 v[36:37], v6, s[40:43], s52 offen offset:8 sc1
    buffer_load_dwordx2 v[38:39], v6, s[40:43], s52 offen offset:1032 sc1
    s_waitcnt vmcnt(12)
    s_waitcnt lgkmcnt(10)
    v_mfma_f32_16x16x32_bf16 v[88:91], v[132:135], v[56:59], v[88:91]
    ds_read_b64_tr_b16 v[124:125], v15 offset:4096
    v_mfma_f32_16x16x32_bf16 v[104:107], v[132:135], v[60:63], v[104:107]
    ds_read_b64_tr_b16 v[126:127], v15 offset:6144
    v_add_u32 v16, 0, v8
    v_add_u32 v17, 0, v9
    v_add_u32 v18, 0, v10
    v_add_u32 v19, 0, v11
    v_mfma_f32_16x16x32_bf16 v[92:95], v[136:139], v[56:59], v[92:95]
    ds_read_b64_tr_b16 v[128:129], v16 offset:0
    v_mfma_f32_16x16x32_bf16 v[108:111], v[136:139], v[60:63], v[108:111]
    ds_read_b64_tr_b16 v[130:131], v16 offset:2048
    s_waitcnt lgkmcnt(10)
    v_mfma_f32_16x16x32_bf16 v[96:99], v[140:143], v[56:59], v[96:99]
    ds_read_b64_tr_b16 v[132:133], v17 offset:0
    v_mfma_f32_16x16x32_bf16 v[112:115], v[140:143], v[60:63], v[112:115]
    ds_read_b64_tr_b16 v[134:135], v17 offset:2048
    v_mfma_f32_16x16x32_bf16 v[100:103], v[144:147], v[56:59], v[100:103]
    ds_read_b64_tr_b16 v[136:137], v18 offset:0
    v_mfma_f32_16x16x32_bf16 v[116:119], v[144:147], v[60:63], v[116:119]
    ds_read_b64_tr_b16 v[138:139], v18 offset:2048
    buffer_load_dwordx4 v[40:43], v6, s[28:31], s46 offen offset:2048 sc1
    buffer_load_dwordx4 v[44:47], v6, s[28:31], s47 offen offset:2048 sc1
    s_waitcnt vmcnt(12)
    s_waitcnt lgkmcnt(10)
    v_mfma_f32_16x16x32_bf16 v[88:91], v[148:151], v[64:67], v[88:91]
    ds_read_b64_tr_b16 v[140:141], v19 offset:0
    v_mfma_f32_16x16x32_bf16 v[104:107], v[148:151], v[68:71], v[104:107]
    ds_read_b64_tr_b16 v[142:143], v19 offset:2048
    v_mfma_f32_16x16x32_bf16 v[92:95], v[152:155], v[64:67], v[92:95]
    ds_read_b64_tr_b16 v[144:145], v16 offset:4096
    v_mfma_f32_16x16x32_bf16 v[108:111], v[152:155], v[68:71], v[108:111]
    ds_read_b64_tr_b16 v[146:147], v16 offset:6144
    s_waitcnt lgkmcnt(10)
    v_mfma_f32_16x16x32_bf16 v[96:99], v[120:123], v[64:67], v[96:99]
    ds_read_b64_tr_b16 v[148:149], v17 offset:4096
    v_mfma_f32_16x16x32_bf16 v[112:115], v[120:123], v[68:71], v[112:115]
    ds_read_b64_tr_b16 v[150:151], v17 offset:6144
    v_mfma_f32_16x16x32_bf16 v[100:103], v[124:127], v[64:67], v[100:103]
    ds_read_b64_tr_b16 v[152:153], v18 offset:4096
    v_mfma_f32_16x16x32_bf16 v[116:119], v[124:127], v[68:71], v[116:119]
    ds_read_b64_tr_b16 v[154:155], v18 offset:6144
    buffer_load_dwordx4 v[48:51], v6, s[28:31], s46 offen offset:3072 sc1
    buffer_load_dwordx4 v[52:55], v6, s[28:31], s47 offen offset:3072 sc1
    s_waitcnt vmcnt(12)
    s_waitcnt lgkmcnt(10)
    v_mfma_f32_16x16x32_bf16 v[88:91], v[128:131], v[72:75], v[88:91]
    ds_read_b64_tr_b16 v[120:121], v19 offset:4096
    v_mfma_f32_16x16x32_bf16 v[104:107], v[128:131], v[76:79], v[104:107]
    ds_read_b64_tr_b16 v[122:123], v19 offset:6144
    v_add_u32 v12, 16384, v8
    v_add_u32 v13, 16384, v9
    v_add_u32 v14, 16384, v10
    v_add_u32 v15, 16384, v11
    v_mfma_f32_16x16x32_bf16 v[92:95], v[132:135], v[72:75], v[92:95]
    ds_read_b64_tr_b16 v[124:125], v12 offset:0
    v_mfma_f32_16x16x32_bf16 v[108:111], v[132:135], v[76:79], v[108:111]
    ds_read_b64_tr_b16 v[126:127], v12 offset:2048
    s_waitcnt lgkmcnt(10)
    v_mfma_f32_16x16x32_bf16 v[96:99], v[136:139], v[72:75], v[96:99]
    ds_read_b64_tr_b16 v[128:129], v13 offset:0
    v_mfma_f32_16x16x32_bf16 v[112:115], v[136:139], v[76:79], v[112:115]
    ds_read_b64_tr_b16 v[130:131], v13 offset:2048
    v_mfma_f32_16x16x32_bf16 v[100:103], v[140:143], v[72:75], v[100:103]
    ds_read_b64_tr_b16 v[132:133], v14 offset:0
    v_mfma_f32_16x16x32_bf16 v[116:119], v[140:143], v[76:79], v[116:119]
    ds_read_b64_tr_b16 v[134:135], v14 offset:2048
    s_add_u32 s46, s44, 20480
    s_add_u32 s47, s45, 20480
    buffer_load_dwordx4 v[56:59], v6, s[28:31], s46 offen offset:0 sc1
    buffer_load_dwordx4 v[60:63], v6, s[28:31], s47 offen offset:0 sc1
    s_waitcnt vmcnt(12)
    s_waitcnt lgkmcnt(10)
    v_mfma_f32_16x16x32_bf16 v[88:91], v[144:147], v[80:83], v[88:91]
    ds_read_b64_tr_b16 v[136:137], v15 offset:0
    v_mfma_f32_16x16x32_bf16 v[104:107], v[144:147], v[84:87], v[104:107]
    ds_read_b64_tr_b16 v[138:139], v15 offset:2048
    v_mfma_f32_16x16x32_bf16 v[92:95], v[148:151], v[80:83], v[92:95]
    ds_read_b64_tr_b16 v[140:141], v12 offset:4096
    v_mfma_f32_16x16x32_bf16 v[108:111], v[148:151], v[84:87], v[108:111]
    ds_read_b64_tr_b16 v[142:143], v12 offset:6144
    s_waitcnt lgkmcnt(10)
    v_mfma_f32_16x16x32_bf16 v[96:99], v[152:155], v[80:83], v[96:99]
    ds_read_b64_tr_b16 v[144:145], v13 offset:4096
    v_mfma_f32_16x16x32_bf16 v[112:115], v[152:155], v[84:87], v[112:115]
    ds_read_b64_tr_b16 v[146:147], v13 offset:6144
    v_mfma_f32_16x16x32_bf16 v[100:103], v[120:123], v[80:83], v[100:103]
    ds_read_b64_tr_b16 v[148:149], v14 offset:4096
    v_mfma_f32_16x16x32_bf16 v[116:119], v[120:123], v[84:87], v[116:119]
    ds_read_b64_tr_b16 v[150:151], v14 offset:6144
    buffer_load_dwordx4 v[64:67], v6, s[28:31], s46 offen offset:1024 sc1
    buffer_load_dwordx4 v[68:71], v6, s[28:31], s47 offen offset:1024 sc1
    s_waitcnt vmcnt(12)
    s_waitcnt lgkmcnt(10)
    v_mfma_f32_16x16x32_bf16 v[88:91], v[124:127], v[24:27], v[88:91]
    ds_read_b64_tr_b16 v[152:153], v15 offset:4096
    v_mfma_f32_16x16x32_bf16 v[104:107], v[124:127], v[28:31], v[104:107]
    ds_read_b64_tr_b16 v[154:155], v15 offset:6144
    v_add_u32 v16, 32768, v8
    v_add_u32 v17, 32768, v9
    v_add_u32 v18, 32768, v10
    v_add_u32 v19, 32768, v11
    v_mfma_f32_16x16x32_bf16 v[92:95], v[128:131], v[24:27], v[92:95]
    ds_read_b64_tr_b16 v[120:121], v16 offset:0
    v_mfma_f32_16x16x32_bf16 v[108:111], v[128:131], v[28:31], v[108:111]
    ds_read_b64_tr_b16 v[122:123], v16 offset:2048
    s_waitcnt lgkmcnt(10)
    v_mfma_f32_16x16x32_bf16 v[96:99], v[132:135], v[24:27], v[96:99]
    ds_read_b64_tr_b16 v[124:125], v17 offset:0
    v_mfma_f32_16x16x32_bf16 v[112:115], v[132:135], v[28:31], v[112:115]
    ds_read_b64_tr_b16 v[126:127], v17 offset:2048
    v_mfma_f32_16x16x32_bf16 v[100:103], v[136:139], v[24:27], v[100:103]
    ds_read_b64_tr_b16 v[128:129], v18 offset:0
    v_mfma_f32_16x16x32_bf16 v[116:119], v[136:139], v[28:31], v[116:119]
    ds_read_b64_tr_b16 v[130:131], v18 offset:2048
    buffer_load_dwordx4 v[72:75], v6, s[28:31], s46 offen offset:2048 sc1
    buffer_load_dwordx4 v[76:79], v6, s[28:31], s47 offen offset:2048 sc1
    s_waitcnt vmcnt(10)
    s_waitcnt lgkmcnt(10)
    v_mfma_f32_16x16x32_bf16 v[88:91], v[140:143], v[32:35], v[88:91]
    ds_read_b64_tr_b16 v[132:133], v19 offset:0
    v_mfma_f32_16x16x32_bf16 v[104:107], v[140:143], v[36:39], v[104:107]
    ds_read_b64_tr_b16 v[134:135], v19 offset:2048
    v_mfma_f32_16x16x32_bf16 v[92:95], v[144:147], v[32:35], v[92:95]
    ds_read_b64_tr_b16 v[136:137], v16 offset:4096
    v_mfma_f32_16x16x32_bf16 v[108:111], v[144:147], v[36:39], v[108:111]
    ds_read_b64_tr_b16 v[138:139], v16 offset:6144
    s_waitcnt lgkmcnt(10)
    v_mfma_f32_16x16x32_bf16 v[96:99], v[148:151], v[32:35], v[96:99]
    ds_read_b64_tr_b16 v[140:141], v17 offset:4096
    v_mfma_f32_16x16x32_bf16 v[112:115], v[148:151], v[36:39], v[112:115]
    ds_read_b64_tr_b16 v[142:143], v17 offset:6144
    v_mfma_f32_16x16x32_bf16 v[100:103], v[152:155], v[32:35], v[100:103]
    ds_read_b64_tr_b16 v[144:145], v18 offset:4096
    v_mfma_f32_16x16x32_bf16 v[116:119], v[152:155], v[36:39], v[116:119]
    ds_read_b64_tr_b16 v[146:147], v18 offset:6144
    buffer_load_dwordx4 v[80:83], v6, s[28:31], s46 offen offset:3072 sc1
    buffer_load_dwordx4 v[84:87], v6, s[28:31], s47 offen offset:3072 sc1
    s_waitcnt vmcnt(10)
    s_waitcnt lgkmcnt(10)
    v_mfma_f32_16x16x32_bf16 v[88:91], v[120:123], v[40:43], v[88:91]
    ds_read_b64_tr_b16 v[148:149], v19 offset:4096
    v_mfma_f32_16x16x32_bf16 v[104:107], v[120:123], v[44:47], v[104:107]
    ds_read_b64_tr_b16 v[150:151], v19 offset:6144
    s_barrier
    v_add_u32 v12, 49152, v8
    v_add_u32 v13, 49152, v9
    v_add_u32 v14, 49152, v10
    v_add_u32 v15, 49152, v11
    v_mfma_f32_16x16x32_bf16 v[92:95], v[124:127], v[40:43], v[92:95]
    ds_read_b64_tr_b16 v[152:153], v12 offset:0
    v_mfma_f32_16x16x32_bf16 v[108:111], v[124:127], v[44:47], v[108:111]
    ds_read_b64_tr_b16 v[154:155], v12 offset:2048
    s_waitcnt lgkmcnt(10)
    v_mfma_f32_16x16x32_bf16 v[96:99], v[128:131], v[40:43], v[96:99]
    ds_read_b64_tr_b16 v[120:121], v13 offset:0
    v_mfma_f32_16x16x32_bf16 v[112:115], v[128:131], v[44:47], v[112:115]
    ds_read_b64_tr_b16 v[122:123], v13 offset:2048
    v_mfma_f32_16x16x32_bf16 v[100:103], v[132:135], v[40:43], v[100:103]
    ds_read_b64_tr_b16 v[124:125], v14 offset:0
    v_mfma_f32_16x16x32_bf16 v[116:119], v[132:135], v[44:47], v[116:119]
    ds_read_b64_tr_b16 v[126:127], v14 offset:2048
    s_add_u32 s46, s44, 24576
    s_add_u32 s47, s45, 24576
    s_add_u32 s52, s51, 6144
    buffer_load_dwordx2 v[24:25], v6, s[40:43], s52 offen offset:0 sc1
    buffer_load_dwordx2 v[26:27], v6, s[40:43], s52 offen offset:1024 sc1
    buffer_load_dwordx2 v[28:29], v6, s[40:43], s52 offen offset:8 sc1
    buffer_load_dwordx2 v[30:31], v6, s[40:43], s52 offen offset:1032 sc1
    s_waitcnt vmcnt(12)
    s_waitcnt lgkmcnt(10)
    v_mfma_f32_16x16x32_bf16 v[88:91], v[136:139], v[48:51], v[88:91]
    ds_read_b64_tr_b16 v[128:129], v15 offset:0
    v_mfma_f32_16x16x32_bf16 v[104:107], v[136:139], v[52:55], v[104:107]
    ds_read_b64_tr_b16 v[130:131], v15 offset:2048
    v_mfma_f32_16x16x32_bf16 v[92:95], v[140:143], v[48:51], v[92:95]
    ds_read_b64_tr_b16 v[132:133], v12 offset:4096
    v_mfma_f32_16x16x32_bf16 v[108:111], v[140:143], v[52:55], v[108:111]
    ds_read_b64_tr_b16 v[134:135], v12 offset:6144
    s_waitcnt lgkmcnt(10)
    v_mfma_f32_16x16x32_bf16 v[96:99], v[144:147], v[48:51], v[96:99]
    ds_read_b64_tr_b16 v[136:137], v13 offset:4096
    v_mfma_f32_16x16x32_bf16 v[112:115], v[144:147], v[52:55], v[112:115]
    ds_read_b64_tr_b16 v[138:139], v13 offset:6144
    v_mfma_f32_16x16x32_bf16 v[100:103], v[148:151], v[48:51], v[100:103]
    ds_read_b64_tr_b16 v[140:141], v14 offset:4096
    v_mfma_f32_16x16x32_bf16 v[116:119], v[148:151], v[52:55], v[116:119]
    ds_read_b64_tr_b16 v[142:143], v14 offset:6144
    buffer_load_dwordx4 v[32:35], v6, s[28:31], s46 offen offset:1024 sc1
    buffer_load_dwordx4 v[36:39], v6, s[28:31], s47 offen offset:1024 sc1
    s_waitcnt vmcnt(12)
    s_waitcnt lgkmcnt(10)
    v_mfma_f32_16x16x32_bf16 v[88:91], v[152:155], v[56:59], v[88:91]
    ds_read_b64_tr_b16 v[144:145], v15 offset:4096
    v_mfma_f32_16x16x32_bf16 v[104:107], v[152:155], v[60:63], v[104:107]
    ds_read_b64_tr_b16 v[146:147], v15 offset:6144
    v_add_u32 v16, 65536, v8
    v_add_u32 v17, 65536, v9
    v_add_u32 v18, 65536, v10
    v_add_u32 v19, 65536, v11
    v_mfma_f32_16x16x32_bf16 v[92:95], v[120:123], v[56:59], v[92:95]
    ds_read_b64_tr_b16 v[148:149], v16 offset:0
    v_mfma_f32_16x16x32_bf16 v[108:111], v[120:123], v[60:63], v[108:111]
    ds_read_b64_tr_b16 v[150:151], v16 offset:2048
    s_waitcnt lgkmcnt(10)
    v_mfma_f32_16x16x32_bf16 v[96:99], v[124:127], v[56:59], v[96:99]
    ds_read_b64_tr_b16 v[152:153], v17 offset:0
    v_mfma_f32_16x16x32_bf16 v[112:115], v[124:127], v[60:63], v[112:115]
    ds_read_b64_tr_b16 v[154:155], v17 offset:2048
    v_mfma_f32_16x16x32_bf16 v[100:103], v[128:131], v[56:59], v[100:103]
    ds_read_b64_tr_b16 v[120:121], v18 offset:0
    v_mfma_f32_16x16x32_bf16 v[116:119], v[128:131], v[60:63], v[116:119]
    ds_read_b64_tr_b16 v[122:123], v18 offset:2048
    buffer_load_dwordx4 v[40:43], v6, s[28:31], s46 offen offset:2048 sc1
    buffer_load_dwordx4 v[44:47], v6, s[28:31], s47 offen offset:2048 sc1
    s_waitcnt vmcnt(12)
    s_waitcnt lgkmcnt(10)
    v_mfma_f32_16x16x32_bf16 v[88:91], v[132:135], v[64:67], v[88:91]
    ds_read_b64_tr_b16 v[124:125], v19 offset:0
    v_mfma_f32_16x16x32_bf16 v[104:107], v[132:135], v[68:71], v[104:107]
    ds_read_b64_tr_b16 v[126:127], v19 offset:2048
    v_mfma_f32_16x16x32_bf16 v[92:95], v[136:139], v[64:67], v[92:95]
    ds_read_b64_tr_b16 v[128:129], v16 offset:4096
    v_mfma_f32_16x16x32_bf16 v[108:111], v[136:139], v[68:71], v[108:111]
    ds_read_b64_tr_b16 v[130:131], v16 offset:6144
    s_waitcnt lgkmcnt(10)
    v_mfma_f32_16x16x32_bf16 v[96:99], v[140:143], v[64:67], v[96:99]
    ds_read_b64_tr_b16 v[132:133], v17 offset:4096
    v_mfma_f32_16x16x32_bf16 v[112:115], v[140:143], v[68:71], v[112:115]
    ds_read_b64_tr_b16 v[134:135], v17 offset:6144
    v_mfma_f32_16x16x32_bf16 v[100:103], v[144:147], v[64:67], v[100:103]
    ds_read_b64_tr_b16 v[136:137], v18 offset:4096
    v_mfma_f32_16x16x32_bf16 v[116:119], v[144:147], v[68:71], v[116:119]
    ds_read_b64_tr_b16 v[138:139], v18 offset:6144
    buffer_load_dwordx4 v[48:51], v6, s[28:31], s46 offen offset:3072 sc1
    buffer_load_dwordx4 v[52:55], v6, s[28:31], s47 offen offset:3072 sc1
    s_waitcnt vmcnt(12)
    s_waitcnt lgkmcnt(10)
    v_mfma_f32_16x16x32_bf16 v[88:91], v[148:151], v[72:75], v[88:91]
    ds_read_b64_tr_b16 v[140:141], v19 offset:4096
    v_mfma_f32_16x16x32_bf16 v[104:107], v[148:151], v[76:79], v[104:107]
    ds_read_b64_tr_b16 v[142:143], v19 offset:6144
    v_add_u32 v12, 81920, v8
    v_add_u32 v13, 81920, v9
    v_add_u32 v14, 81920, v10
    v_add_u32 v15, 81920, v11
    v_mfma_f32_16x16x32_bf16 v[92:95], v[152:155], v[72:75], v[92:95]
    ds_read_b64_tr_b16 v[144:145], v12 offset:0
    v_mfma_f32_16x16x32_bf16 v[108:111], v[152:155], v[76:79], v[108:111]
    ds_read_b64_tr_b16 v[146:147], v12 offset:2048
    s_waitcnt lgkmcnt(10)
    v_mfma_f32_16x16x32_bf16 v[96:99], v[120:123], v[72:75], v[96:99]
    ds_read_b64_tr_b16 v[148:149], v13 offset:0
    v_mfma_f32_16x16x32_bf16 v[112:115], v[120:123], v[76:79], v[112:115]
    ds_read_b64_tr_b16 v[150:151], v13 offset:2048
    v_mfma_f32_16x16x32_bf16 v[100:103], v[124:127], v[72:75], v[100:103]
    ds_read_b64_tr_b16 v[152:153], v14 offset:0
    v_mfma_f32_16x16x32_bf16 v[116:119], v[124:127], v[76:79], v[116:119]
    ds_read_b64_tr_b16 v[154:155], v14 offset:2048
    buffer_load_dwordx4 a[0:3], v7, s[32:35], s48 offen offset:0 sc1
    buffer_load_dwordx4 a[4:7], v7, s[32:35], s48 offen offset:64 sc1
    s_waitcnt vmcnt(12)
    s_waitcnt lgkmcnt(10)
    v_mfma_f32_16x16x32_bf16 v[88:91], v[128:131], v[80:83], v[88:91]
    ds_read_b64_tr_b16 v[120:121], v15 offset:0
    v_mfma_f32_16x16x32_bf16 v[104:107], v[128:131], v[84:87], v[104:107]
    ds_read_b64_tr_b16 v[122:123], v15 offset:2048
    v_mfma_f32_16x16x32_bf16 v[92:95], v[132:135], v[80:83], v[92:95]
    ds_read_b64_tr_b16 v[124:125], v12 offset:4096
    v_mfma_f32_16x16x32_bf16 v[108:111], v[132:135], v[84:87], v[108:111]
    ds_read_b64_tr_b16 v[126:127], v12 offset:6144
    s_waitcnt lgkmcnt(10)
    v_mfma_f32_16x16x32_bf16 v[96:99], v[136:139], v[80:83], v[96:99]
    ds_read_b64_tr_b16 v[128:129], v13 offset:4096
    v_mfma_f32_16x16x32_bf16 v[112:115], v[136:139], v[84:87], v[112:115]
    ds_read_b64_tr_b16 v[130:131], v13 offset:6144
    v_mfma_f32_16x16x32_bf16 v[100:103], v[140:143], v[80:83], v[100:103]
    ds_read_b64_tr_b16 v[132:133], v14 offset:4096
    v_mfma_f32_16x16x32_bf16 v[116:119], v[140:143], v[84:87], v[116:119]
    ds_read_b64_tr_b16 v[134:135], v14 offset:6144
    s_waitcnt vmcnt(8)
    s_waitcnt lgkmcnt(10)
    v_mfma_f32_16x16x32_bf16 v[88:91], v[144:147], v[24:27], v[88:91]
    ds_read_b64_tr_b16 v[136:137], v15 offset:4096
    v_mfma_f32_16x16x32_bf16 v[104:107], v[144:147], v[28:31], v[104:107]
    ds_read_b64_tr_b16 v[138:139], v15 offset:6144
    v_add_u32 v16, 98304, v8
    v_add_u32 v17, 98304, v9
    v_add_u32 v18, 98304, v10
    v_add_u32 v19, 98304, v11
    v_mfma_f32_16x16x32_bf16 v[92:95], v[148:151], v[24:27], v[92:95]
    ds_read_b64_tr_b16 v[140:141], v16 offset:0
    v_mfma_f32_16x16x32_bf16 v[108:111], v[148:151], v[28:31], v[108:111]
    ds_read_b64_tr_b16 v[142:143], v16 offset:2048
    s_waitcnt lgkmcnt(10)
    v_mfma_f32_16x16x32_bf16 v[96:99], v[152:155], v[24:27], v[96:99]
    ds_read_b64_tr_b16 v[144:145], v17 offset:0
    v_mfma_f32_16x16x32_bf16 v[112:115], v[152:155], v[28:31], v[112:115]
    ds_read_b64_tr_b16 v[146:147], v17 offset:2048
    v_mfma_f32_16x16x32_bf16 v[100:103], v[120:123], v[24:27], v[100:103]
    ds_read_b64_tr_b16 v[148:149], v18 offset:0
    v_mfma_f32_16x16x32_bf16 v[116:119], v[120:123], v[28:31], v[116:119]
    ds_read_b64_tr_b16 v[150:151], v18 offset:2048
    s_waitcnt vmcnt(6)
    s_waitcnt lgkmcnt(10)
    v_mfma_f32_16x16x32_bf16 v[88:91], v[124:127], v[32:35], v[88:91]
    ds_read_b64_tr_b16 v[152:153], v19 offset:0
    v_mfma_f32_16x16x32_bf16 v[104:107], v[124:127], v[36:39], v[104:107]
    ds_read_b64_tr_b16 v[154:155], v19 offset:2048
    v_mfma_f32_16x16x32_bf16 v[92:95], v[128:131], v[32:35], v[92:95]
    ds_read_b64_tr_b16 v[120:121], v16 offset:4096
    v_mfma_f32_16x16x32_bf16 v[108:111], v[128:131], v[36:39], v[108:111]
    ds_read_b64_tr_b16 v[122:123], v16 offset:6144
    s_waitcnt lgkmcnt(10)
    v_mfma_f32_16x16x32_bf16 v[96:99], v[132:135], v[32:35], v[96:99]
    ds_read_b64_tr_b16 v[124:125], v17 offset:4096
    v_mfma_f32_16x16x32_bf16 v[112:115], v[132:135], v[36:39], v[112:115]
    ds_read_b64_tr_b16 v[126:127], v17 offset:6144
    v_mfma_f32_16x16x32_bf16 v[100:103], v[136:139], v[32:35], v[100:103]
    ds_read_b64_tr_b16 v[128:129], v18 offset:4096
    v_mfma_f32_16x16x32_bf16 v[116:119], v[136:139], v[36:39], v[116:119]
    ds_read_b64_tr_b16 v[130:131], v18 offset:6144
    s_waitcnt vmcnt(4)
    s_waitcnt lgkmcnt(10)
    v_mfma_f32_16x16x32_bf16 v[88:91], v[140:143], v[40:43], v[88:91]
    ds_read_b64_tr_b16 v[132:133], v19 offset:4096
    v_mfma_f32_16x16x32_bf16 v[104:107], v[140:143], v[44:47], v[104:107]
    ds_read_b64_tr_b16 v[134:135], v19 offset:6144
    v_mfma_f32_16x16x32_bf16 v[92:95], v[144:147], v[40:43], v[92:95]
    v_mfma_f32_16x16x32_bf16 v[108:111], v[144:147], v[44:47], v[108:111]
    s_waitcnt lgkmcnt(8)
    v_mfma_f32_16x16x32_bf16 v[96:99], v[148:151], v[40:43], v[96:99]
    v_mfma_f32_16x16x32_bf16 v[112:115], v[148:151], v[44:47], v[112:115]
    v_mfma_f32_16x16x32_bf16 v[100:103], v[152:155], v[40:43], v[100:103]
    v_mfma_f32_16x16x32_bf16 v[116:119], v[152:155], v[44:47], v[116:119]
    s_waitcnt vmcnt(2)
    s_waitcnt lgkmcnt(4)
    v_mfma_f32_16x16x32_bf16 v[88:91], v[120:123], v[48:51], v[88:91]
    v_mfma_f32_16x16x32_bf16 v[104:107], v[120:123], v[52:55], v[104:107]
    v_mfma_f32_16x16x32_bf16 v[92:95], v[124:127], v[48:51], v[92:95]
    v_mfma_f32_16x16x32_bf16 v[108:111], v[124:127], v[52:55], v[108:111]
    s_waitcnt lgkmcnt(0)
    v_mfma_f32_16x16x32_bf16 v[96:99], v[128:131], v[48:51], v[96:99]
    v_mfma_f32_16x16x32_bf16 v[112:115], v[128:131], v[52:55], v[112:115]
    v_mfma_f32_16x16x32_bf16 v[100:103], v[132:135], v[48:51], v[100:103]
    v_mfma_f32_16x16x32_bf16 v[116:119], v[132:135], v[52:55], v[116:119]
    s_cmp_eq_u32 s50, 0
    s_cbranch_scc0 F_x1
    ds_write_b128 v22, v[104:107] offset:0
    ds_write_b128 v22, v[108:111] offset:1024
    s_nop 1
    ds_write_b128 v22, v[112:115] offset:2048
    s_nop 0
    ds_write_b128 v22, v[116:119] offset:3072
    v_mov_b32 v120, v88
    v_mov_b32 v121, v89
    v_mov_b32 v122, v90
    v_mov_b32 v123, v91
    v_mov_b32 v124, v92
    v_mov_b32 v125, v93
    v_mov_b32 v126, v94
    v_mov_b32 v127, v95
    v_mov_b32 v128, v96
    v_mov_b32 v129, v97
    v_mov_b32 v130, v98
    v_mov_b32 v131, v99
    v_mov_b32 v132, v100
    v_mov_b32 v133, v101
    v_mov_b32 v134, v102
    v_mov_b32 v135, v103
    s_branch F_x2
F_x1:
    ds_write_b128 v22, v[88:91] offset:0
    ds_write_b128 v22, v[92:95] offset:1024
    s_nop 0
    ds_write_b128 v22, v[96:99] offset:2048
    s_nop 0
    ds_write_b128 v22, v[100:103] offset:3072
    v_mov_b32 v120, v104
    v_mov_b32 v121, v105
    v_mov_b32 v122, v106
    v_mov_b32 v123, v107
    v_mov_b32 v124, v108
    v_mov_b32 v125, v109
    v_mov_b32 v126, v110
    v_mov_b32 v127, v111
    v_mov_b32 v128, v112
    v_mov_b32 v129, v113
    v_mov_b32 v130, v114
    v_mov_b32 v131, v115
    v_mov_b32 v132, v116
    v_mov_b32 v133, v117
    v_mov_b32 v134, v118
    v_mov_b32 v135, v119
F_x2:
    s_waitcnt lgkmcnt(0)
    s_barrier
    ds_read_b128 v[136:139], v23 offset:0
    ds_read_b128 v[140:143], v23 offset:1024
    ds_read_b128 v[144:147], v23 offset:2048
    ds_read_b128 v[148:151], v23 offset:3072
    s_waitcnt lgkmcnt(3)
    v_pk_add_f32 v[120:121], v[120:121], v[136:137]
    v_pk_add_f32 v[122:123], v[122:123], v[138:139]
    s_waitcnt lgkmcnt(2)
    v_pk_add_f32 v[124:125], v[124:125], v[140:141]
    v_pk_add_f32 v[126:127], v[126:127], v[142:143]
    s_waitcnt lgkmcnt(1)
    v_pk_add_f32 v[128:129], v[128:129], v[144:145]
    v_pk_add_f32 v[130:131], v[130:131], v[146:147]
    s_waitcnt lgkmcnt(0)
    v_pk_add_f32 v[132:133], v[132:133], v[148:149]
    v_pk_add_f32 v[134:135], v[134:135], v[150:151]
    v_permlane16_swap_b32 v120, v124
    v_permlane16_swap_b32 v121, v125
    v_permlane16_swap_b32 v122, v126
    v_permlane16_swap_b32 v123, v127
    v_permlane16_swap_b32 v128, v132
    v_permlane16_swap_b32 v129, v133
    v_permlane16_swap_b32 v130, v134
    v_permlane16_swap_b32 v131, v135
    s_waitcnt vmcnt(0)
    v_accvgpr_read_b32 v104, a0
    v_accvgpr_read_b32 v105, a1
    v_accvgpr_read_b32 v106, a2
    v_accvgpr_read_b32 v107, a3
    v_accvgpr_read_b32 v108, a4
    v_accvgpr_read_b32 v109, a5
    v_accvgpr_read_b32 v110, a6
    v_accvgpr_read_b32 v111, a7
    v_lshlrev_b32 v88, 16, v104
    v_and_b32 v89, 0xffff0000, v104
    v_lshlrev_b32 v90, 16, v105
    v_and_b32 v91, 0xffff0000, v105
    v_lshlrev_b32 v92, 16, v106
    v_and_b32 v93, 0xffff0000, v106
    v_lshlrev_b32 v94, 16, v107
    v_and_b32 v95, 0xffff0000, v107
    v_pk_add_f32 v[88:89], v[88:89], v[120:121]
    v_pk_add_f32 v[90:91], v[90:91], v[122:123]
    v_pk_add_f32 v[92:93], v[92:93], v[124:125]
    v_pk_add_f32 v[94:95], v[94:95], v[126:127]
    v_cvt_pk_bf16_f32 v112, v88, v89
    v_cvt_pk_bf16_f32 v113, v90, v91
    v_cvt_pk_bf16_f32 v114, v92, v93
    v_cvt_pk_bf16_f32 v115, v94, v95
    buffer_store_dwordx4 v[112:115], v7, s[36:39], s48 offen offset:0 sc1
    v_lshlrev_b32 v96, 16, v108
    v_and_b32 v97, 0xffff0000, v108
    v_lshlrev_b32 v98, 16, v109
    v_and_b32 v99, 0xffff0000, v109
    v_lshlrev_b32 v100, 16, v110
    v_and_b32 v101, 0xffff0000, v110
    v_lshlrev_b32 v102, 16, v111
    v_and_b32 v103, 0xffff0000, v111
    v_pk_add_f32 v[96:97], v[96:97], v[128:129]
    v_pk_add_f32 v[98:99], v[98:99], v[130:131]
    v_pk_add_f32 v[100:101], v[100:101], v[132:133]
    v_pk_add_f32 v[102:103], v[102:103], v[134:135]
    v_cvt_pk_bf16_f32 v116, v96, v97
    v_cvt_pk_bf16_f32 v117, v98, v99
    v_cvt_pk_bf16_f32 v118, v100, v101
    v_cvt_pk_bf16_f32 v119, v102, v103
    buffer_store_dwordx4 v[116:119], v7, s[36:39], s48 offen offset:64 sc1
    s_branch F_done
F_loader:
    s_bfe_u32 s40, s16, 0x10001
    s_and_b32 s41, s16, 1
    s_and_b32 s48, s16, 3
    v_mov_b32 v4, v3
    v_mul_u32_u24 v5, 74899, v4
    v_lshrrev_b32 v5, 20, v5
    v_mul_u32_u24 v6, 14, v5
    v_sub_u32 v4, v4, v6
    v_lshlrev_b32 v4, 4, v4
    v_lshrrev_b32 v6, 4, v5
    v_lshlrev_b32 v6, 8, v6
    v_and_b32 v5, 15, v5
    v_add_u32 v5, v5, v6
    v_mul_u32_u24 v6, 3584, v5
    v_add_u32 v6, v6, v4
    v_add_u32 v4, 64, v3
    v_mul_u32_u24 v5, 74899, v4
    v_lshrrev_b32 v5, 20, v5
    v_mul_u32_u24 v7, 14, v5
    v_sub_u32 v4, v4, v7
    v_lshlrev_b32 v4, 4, v4
    v_lshrrev_b32 v7, 4, v5
    v_lshlrev_b32 v7, 8, v7
    v_and_b32 v5, 15, v5
    v_add_u32 v5, v5, v7
    v_mul_u32_u24 v7, 3584, v5
    v_add_u32 v7, v7, v4
    v_subrev_u32 v7, 1024, v7
    v_add_u32 v4, 128, v3
    v_mul_u32_u24 v5, 74899, v4
    v_lshrrev_b32 v5, 20, v5
    v_mul_u32_u24 v8, 14, v5
    v_sub_u32 v4, v4, v8
    v_lshlrev_b32 v4, 4, v4
    v_lshrrev_b32 v8, 4, v5
    v_lshlrev_b32 v8, 8, v8
    v_and_b32 v5, 15, v5
    v_add_u32 v5, v5, v8
    v_mul_u32_u24 v8, 3584, v5
    v_add_u32 v8, v8, v4
    v_subrev_u32 v8, 2048, v8
    v_add_u32 v4, 192, v3
    v_mul_u32_u24 v5, 74899, v4
    v_lshrrev_b32 v5, 20, v5
    v_mul_u32_u24 v9, 14, v5
    v_sub_u32 v4, v4, v9
    v_lshlrev_b32 v4, 4, v4
    v_lshrrev_b32 v9, 4, v5
    v_lshlrev_b32 v9, 8, v9
    v_and_b32 v5, 15, v5
    v_add_u32 v5, v5, v9
    v_mul_u32_u24 v9, 3584, v5
    v_add_u32 v9, v9, v4
    v_subrev_u32 v9, 3072, v9
    v_add_u32 v4, 256, v3
    v_mul_u32_u24 v5, 74899, v4
    v_lshrrev_b32 v5, 20, v5
    v_mul_u32_u24 v10, 14, v5
    v_sub_u32 v4, v4, v10
    v_lshlrev_b32 v4, 4, v4
    v_lshrrev_b32 v10, 4, v5
    v_lshlrev_b32 v10, 8, v10
    v_and_b32 v5, 15, v5
    v_add_u32 v5, v5, v10
    v_mul_u32_u24 v10, 3584, v5
    v_add_u32 v10, v10, v4
    v_add_u32 v4, 320, v3
    v_mul_u32_u24 v5, 74899, v4
    v_lshrrev_b32 v5, 20, v5
    v_mul_u32_u24 v11, 14, v5
    v_sub_u32 v4, v4, v11
    v_lshlrev_b32 v4, 4, v4
    v_lshrrev_b32 v11, 4, v5
    v_lshlrev_b32 v11, 8, v11
    v_and_b32 v5, 15, v5
    v_add_u32 v5, v5, v11
    v_mul_u32_u24 v11, 3584, v5
    v_add_u32 v11, v11, v4
    v_subrev_u32 v11, 1024, v11
    v_add_u32 v4, 384, v3
    v_mul_u32_u24 v5, 74899, v4
    v_lshrrev_b32 v5, 20, v5
    v_mul_u32_u24 v12, 14, v5
    v_sub_u32 v4, v4, v12
    v_lshlrev_b32 v4, 4, v4
    v_lshrrev_b32 v12, 4, v5
    v_lshlrev_b32 v12, 8, v12
    v_and_b32 v5, 15, v5
    v_add_u32 v5, v5, v12
    v_mul_u32_u24 v12, 3584, v5
    v_add_u32 v12, v12, v4
    v_subrev_u32 v12, 2048, v12
    v_lshlrev_b32 v13, 4, v3
    s_mul_i32 s42, s20, 224
    s_mul_i32 s17, s40, 57344
    s_add_u32 s42, s42, s17
    s_lshl_b32 s43, s19, 17
    s_lshl_b32 s17, s41, 16
    s_add_u32 s43, s43, s17
    s_lshl_b32 s17, s40, 10
    s_add_u32 s43, s43, s17
    s_mul_i32 s44, s41, 7168
    s_lshl_b32 s45, s41, 12
    s_add_u32 s45, s45, 14336
    v_lshrrev_b32 v4, 3, v3
    v_bfe_u32 v5, v4, 1, 2
    v_lshlrev_b32 v5, 1, v5
    v_and_b32 v14, 7, v3
    v_xor_b32 v14, v14, v5
    v_lshlrev_b32 v14, 4, v14
    v_lshl_add_u32 v14, v4, 10, v14
    s_lshl_b32 s17, s48, 13
    s_lshl_b32 s18, s22, 7
    s_add_u32 s17, s17, s18
    v_add_u32 v14, s17, v14
    s_lshl_b32 s49, s48, 10
    s_waitcnt lgkmcnt(0)
    s_add_u32 s32, s6, 0xc00000
    s_addc_u32 s33, s7, 0
    s_and_b32 s33, s33, 0xffff
    s_mov_b32 s34, 0x200000
    s_mov_b32 s35, 0x20000
    s_cmp_eq_u32 s41, 0
    s_cselect_b32 s28, s8, s10
    s_cselect_b32 s29, s9, s11
    s_and_b32 s29, s29, 0xffff
    s_mov_b32 s30, 0x1c0000
    s_mov_b32 s31, 0x20000
    s_mov_b32 s36, s12
    s_mov_b32 s37, s13
    s_and_b32 s37, s37, 0xffff
    s_mov_b32 s38, 0x1c0000
    s_mov_b32 s39, 0x20000
    s_barrier
    s_mul_i32 s47, s40, 0x5800
    s_add_u32 s47, s47, 0x0
    s_add_u32 m0, s47, s44
    s_add_u32 s46, s42, 0
    buffer_load_dwordx4 v6, s[28:31], s46 offen offset:0  lds
    buffer_load_dwordx4 v7, s[28:31], s46 offen offset:1024  lds
    buffer_load_dwordx4 v8, s[28:31], s46 offen offset:2048  lds
    buffer_load_dwordx4 v9, s[28:31], s46 offen offset:3072  lds
    s_add_u32 m0, m0, 4096
    s_nop 0
    buffer_load_dwordx4 v10, s[28:31], s46 offen offset:0  lds
    buffer_load_dwordx4 v11, s[28:31], s46 offen offset:1024  lds
    buffer_load_dwordx4 v12, s[28:31], s46 offen offset:2048  lds
    s_mul_i32 s47, s40, 0x5800
    s_add_u32 s47, s47, 0xb000
    s_add_u32 m0, s47, s44
    s_add_u32 s46, s42, 114688
    buffer_load_dwordx4 v6, s[28:31], s46 offen offset:0  lds
    buffer_load_dwordx4 v7, s[28:31], s46 offen offset:1024  lds
    buffer_load_dwordx4 v8, s[28:31], s46 offen offset:2048  lds
    buffer_load_dwordx4 v9, s[28:31], s46 offen offset:3072  lds
    s_add_u32 m0, m0, 4096
    s_nop 0
    buffer_load_dwordx4 v10, s[28:31], s46 offen offset:0  lds
    buffer_load_dwordx4 v11, s[28:31], s46 offen offset:1024  lds
    buffer_load_dwordx4 v12, s[28:31], s46 offen offset:2048  lds
    s_barrier
    s_mul_i32 s47, s40, 0x5800
    s_add_u32 s47, s47, 0x16000
    s_add_u32 m0, s47, s44
    s_add_u32 s46, s42, 229376
    buffer_load_dwordx4 v6, s[28:31], s46 offen offset:0  lds
    buffer_load_dwordx4 v7, s[28:31], s46 offen offset:1024  lds
    buffer_load_dwordx4 v8, s[28:31], s46 offen offset:2048  lds
    buffer_load_dwordx4 v9, s[28:31], s46 offen offset:3072  lds
    s_add_u32 m0, m0, 4096
    s_nop 0
    buffer_load_dwordx4 v10, s[28:31], s46 offen offset:0  lds
    buffer_load_dwordx4 v11, s[28:31], s46 offen offset:1024  lds
    buffer_load_dwordx4 v12, s[28:31], s46 offen offset:2048  lds
    s_barrier
    s_mov_b32 s46, 655360
    buffer_load_dwordx4 v[20:23], v14, s[36:39], s46 offen
    s_mov_b32 s46, 688128
    buffer_load_dwordx4 v[24:27], v14, s[36:39], s46 offen
    s_mov_b32 s46, 1572864
    buffer_load_dwordx4 v[28:31], v14, s[36:39], s46 offen
    s_mov_b32 s46, 1605632
    buffer_load_dwordx4 v[32:35], v14, s[36:39], s46 offen
    s_mov_b32 s46, 720896
    buffer_load_dwordx4 v[36:39], v14, s[36:39], s46 offen
    s_mov_b32 s46, 753664
    buffer_load_dwordx4 v[40:43], v14, s[36:39], s46 offen
    s_mov_b32 s46, 1638400
    buffer_load_dwordx4 v[44:47], v14, s[36:39], s46 offen
    s_mov_b32 s46, 1671168
    buffer_load_dwordx4 v[48:51], v14, s[36:39], s46 offen
    s_mov_b32 s46, 786432
    buffer_load_dwordx4 v[52:55], v14, s[36:39], s46 offen
    s_mov_b32 s46, 819200
    buffer_load_dwordx4 v[56:59], v14, s[36:39], s46 offen
    s_mov_b32 s46, 1703936
    buffer_load_dwordx4 v[60:63], v14, s[36:39], s46 offen
    s_mov_b32 s46, 1736704
    buffer_load_dwordx4 v[64:67], v14, s[36:39], s46 offen
    s_mov_b32 s46, 851968
    buffer_load_dwordx4 v[68:71], v14, s[36:39], s46 offen
    s_mov_b32 s46, 884736
    buffer_load_dwordx4 v[72:75], v14, s[36:39], s46 offen
    s_mov_b32 s46, 1769472
    buffer_load_dwordx4 v[76:79], v14, s[36:39], s46 offen
    s_mov_b32 s46, 1802240
    buffer_load_dwordx4 v[80:83], v14, s[36:39], s46 offen
    s_barrier
    s_mul_i32 s47, s40, 0x5800
    s_add_u32 s47, s47, 0x0
    s_add_u32 m0, s47, s45
    s_add_u32 s46, s43, 0
    buffer_load_dwordx4 v13, s[32:35], s46 offen offset:0 sc1 lds
    s_add_u32 s46, s43, 15360
    buffer_load_dwordx4 v13, s[32:35], s46 offen offset:1024 sc1 lds
    s_add_u32 s46, s43, 30720
    buffer_load_dwordx4 v13, s[32:35], s46 offen offset:2048 sc1 lds
    s_add_u32 s46, s43, 46080
    buffer_load_dwordx4 v13, s[32:35], s46 offen offset:3072 sc1 lds
    s_mul_i32 s47, s40, 0x5800
    s_add_u32 s47, s47, 0xb000
    s_add_u32 m0, s47, s45
    s_add_u32 s46, s43, 2048
    buffer_load_dwordx4 v13, s[32:35], s46 offen offset:0 sc1 lds
    s_add_u32 s46, s43, 17408
    buffer_load_dwordx4 v13, s[32:35], s46 offen offset:1024 sc1 lds
    s_add_u32 s46, s43, 32768
    buffer_load_dwordx4 v13, s[32:35], s46 offen offset:2048 sc1 lds
    s_add_u32 s46, s43, 48128
    buffer_load_dwordx4 v13, s[32:35], s46 offen offset:3072 sc1 lds
    s_mul_i32 s47, s40, 0x5800
    s_add_u32 s47, s47, 0x16000
    s_add_u32 m0, s47, s45
    s_add_u32 s46, s43, 4096
    buffer_load_dwordx4 v13, s[32:35], s46 offen offset:0 sc1 lds
    s_add_u32 s46, s43, 19456
    buffer_load_dwordx4 v13, s[32:35], s46 offen offset:1024 sc1 lds
    s_add_u32 s46, s43, 34816
    buffer_load_dwordx4 v13, s[32:35], s46 offen offset:2048 sc1 lds
    s_add_u32 s46, s43, 50176
    buffer_load_dwordx4 v13, s[32:35], s46 offen offset:3072 sc1 lds
    s_cmp_eq_u32 s40, 0
    s_cbranch_scc0 F_l0
    s_waitcnt vmcnt(8)
F_l0:
    s_barrier
    s_waitcnt vmcnt(8)
    s_barrier
    s_waitcnt vmcnt(4)
    s_barrier
    s_mul_i32 s47, s40, 0xfffdf000
    s_add_u32 s47, s47, 0x21000
    s_add_u32 m0, s47, s45
    s_add_u32 s46, s43, 6144
    buffer_load_dwordx4 v13, s[32:35], s46 offen offset:0 sc1 lds
    s_add_u32 s46, s43, 21504
    buffer_load_dwordx4 v13, s[32:35], s46 offen offset:1024 sc1 lds
    s_add_u32 s46, s43, 36864
    buffer_load_dwordx4 v13, s[32:35], s46 offen offset:2048 sc1 lds
    s_add_u32 s46, s43, 52224
    buffer_load_dwordx4 v13, s[32:35], s46 offen offset:3072 sc1 lds
    s_mul_i32 s47, s40, 0xfffdf000
    s_add_u32 s47, s47, 0x21000
    s_add_u32 m0, s47, s44
    s_add_u32 s46, s42, 344064
    buffer_load_dwordx4 v6, s[28:31], s46 offen offset:0  lds
    buffer_load_dwordx4 v7, s[28:31], s46 offen offset:1024  lds
    buffer_load_dwordx4 v8, s[28:31], s46 offen offset:2048  lds
    buffer_load_dwordx4 v9, s[28:31], s46 offen offset:3072  lds
    s_add_u32 m0, m0, 4096
    s_nop 0
    buffer_load_dwordx4 v10, s[28:31], s46 offen offset:0  lds
    buffer_load_dwordx4 v11, s[28:31], s46 offen offset:1024  lds
    buffer_load_dwordx4 v12, s[28:31], s46 offen offset:2048  lds
    s_waitcnt vmcnt(11)
    s_barrier
    s_mul_i32 s47, s40, 0x5800
    s_add_u32 s47, s47, 0x5800
    s_add_u32 m0, s47, s45
    s_add_u32 s46, s43, 8192
    buffer_load_dwordx4 v13, s[32:35], s46 offen offset:0 sc1 lds
    s_add_u32 s46, s43, 23552
    buffer_load_dwordx4 v13, s[32:35], s46 offen offset:1024 sc1 lds
    s_add_u32 s46, s43, 38912
    buffer_load_dwordx4 v13, s[32:35], s46 offen offset:2048 sc1 lds
    s_add_u32 s46, s43, 54272
    buffer_load_dwordx4 v13, s[32:35], s46 offen offset:3072 sc1 lds
    s_mul_i32 s47, s40, 0x5800
    s_add_u32 s47, s47, 0x5800
    s_add_u32 m0, s47, s44
    s_add_u32 s46, s42, 458752
    buffer_load_dwordx4 v6, s[28:31], s46 offen offset:0  lds
    buffer_load_dwordx4 v7, s[28:31], s46 offen offset:1024  lds
    buffer_load_dwordx4 v8, s[28:31], s46 offen offset:2048  lds
    buffer_load_dwordx4 v9, s[28:31], s46 offen offset:3072  lds
    s_add_u32 m0, m0, 4096
    s_nop 0
    buffer_load_dwordx4 v10, s[28:31], s46 offen offset:0  lds
    buffer_load_dwordx4 v11, s[28:31], s46 offen offset:1024  lds
    buffer_load_dwordx4 v12, s[28:31], s46 offen offset:2048  lds
    s_waitcnt vmcnt(11)
    s_barrier
    s_mul_i32 s47, s40, 0x5800
    s_add_u32 s47, s47, 0x10800
    s_add_u32 m0, s47, s45
    s_add_u32 s46, s43, 10240
    buffer_load_dwordx4 v13, s[32:35], s46 offen offset:0 sc1 lds
    s_add_u32 s46, s43, 25600
    buffer_load_dwordx4 v13, s[32:35], s46 offen offset:1024 sc1 lds
    s_add_u32 s46, s43, 40960
    buffer_load_dwordx4 v13, s[32:35], s46 offen offset:2048 sc1 lds
    s_add_u32 s46, s43, 56320
    buffer_load_dwordx4 v13, s[32:35], s46 offen offset:3072 sc1 lds
    s_mul_i32 s47, s40, 0x5800
    s_add_u32 s47, s47, 0x10800
    s_add_u32 m0, s47, s44
    s_add_u32 s46, s42, 573440
    buffer_load_dwordx4 v6, s[28:31], s46 offen offset:0  lds
    buffer_load_dwordx4 v7, s[28:31], s46 offen offset:1024  lds
    buffer_load_dwordx4 v8, s[28:31], s46 offen offset:2048  lds
    buffer_load_dwordx4 v9, s[28:31], s46 offen offset:3072  lds
    s_add_u32 m0, m0, 4096
    s_nop 0
    buffer_load_dwordx4 v10, s[28:31], s46 offen offset:0  lds
    buffer_load_dwordx4 v11, s[28:31], s46 offen offset:1024  lds
    buffer_load_dwordx4 v12, s[28:31], s46 offen offset:2048  lds
    s_waitcnt vmcnt(11)
    s_barrier
    s_mul_i32 s47, s40, 0x5800
    s_add_u32 s47, s47, 0x1b800
    s_add_u32 m0, s47, s45
    s_add_u32 s46, s43, 12288
    buffer_load_dwordx4 v13, s[32:35], s46 offen offset:0 sc1 lds
    s_add_u32 s46, s43, 27648
    buffer_load_dwordx4 v13, s[32:35], s46 offen offset:1024 sc1 lds
    s_add_u32 s46, s43, 43008
    buffer_load_dwordx4 v13, s[32:35], s46 offen offset:2048 sc1 lds
    s_add_u32 s46, s43, 58368
    buffer_load_dwordx4 v13, s[32:35], s46 offen offset:3072 sc1 lds
    s_mul_i32 s47, s40, 0x5800
    s_add_u32 s47, s47, 0x1b800
    s_add_u32 m0, s47, s44
    s_add_u32 s46, s42, 688128
    buffer_load_dwordx4 v6, s[28:31], s46 offen offset:0  lds
    buffer_load_dwordx4 v7, s[28:31], s46 offen offset:1024  lds
    buffer_load_dwordx4 v8, s[28:31], s46 offen offset:2048  lds
    buffer_load_dwordx4 v9, s[28:31], s46 offen offset:3072  lds
    s_add_u32 m0, m0, 4096
    s_nop 0
    buffer_load_dwordx4 v10, s[28:31], s46 offen offset:0  lds
    buffer_load_dwordx4 v11, s[28:31], s46 offen offset:1024  lds
    buffer_load_dwordx4 v12, s[28:31], s46 offen offset:2048  lds
    s_waitcnt vmcnt(11)
    s_barrier
    s_mul_i32 s47, s40, 0x5800
    s_add_u32 s47, s47, 0x0
    s_add_u32 m0, s47, s45
    s_add_u32 s46, s43, 14336
    buffer_load_dwordx4 v13, s[32:35], s46 offen offset:0 sc1 lds
    s_add_u32 s46, s43, 29696
    buffer_load_dwordx4 v13, s[32:35], s46 offen offset:1024 sc1 lds
    s_add_u32 s46, s43, 45056
    buffer_load_dwordx4 v13, s[32:35], s46 offen offset:2048 sc1 lds
    s_add_u32 s46, s43, 60416
    buffer_load_dwordx4 v13, s[32:35], s46 offen offset:3072 sc1 lds
    s_mul_i32 s47, s40, 0x5800
    s_add_u32 s47, s47, 0x0
    s_add_u32 m0, s47, s44
    s_add_u32 s46, s42, 802816
    buffer_load_dwordx4 v6, s[28:31], s46 offen offset:0  lds
    buffer_load_dwordx4 v7, s[28:31], s46 offen offset:1024  lds
    buffer_load_dwordx4 v8, s[28:31], s46 offen offset:2048  lds
    buffer_load_dwordx4 v9, s[28:31], s46 offen offset:3072  lds
    s_add_u32 m0, m0, 4096
    s_nop 0
    buffer_load_dwordx4 v10, s[28:31], s46 offen offset:0  lds
    buffer_load_dwordx4 v11, s[28:31], s46 offen offset:1024  lds
    buffer_load_dwordx4 v12, s[28:31], s46 offen offset:2048  lds
    s_waitcnt vmcnt(11)
    s_barrier
    s_waitcnt vmcnt(0)
    s_barrier
    s_add_u32 m0, s49, 49152
    s_mov_b32 s46, 0
    buffer_load_dwordx4 v14, s[36:39], s46 offen  lds
    s_add_u32 m0, s49, 53248
    s_mov_b32 s46, 32768
    buffer_load_dwordx4 v14, s[36:39], s46 offen  lds
    s_add_u32 m0, s49, 57344
    s_mov_b32 s46, 917504
    buffer_load_dwordx4 v14, s[36:39], s46 offen  lds
    s_add_u32 m0, s49, 61440
    s_mov_b32 s46, 950272
    buffer_load_dwordx4 v14, s[36:39], s46 offen  lds
    s_add_u32 m0, s49, 65536
    s_mov_b32 s46, 65536
    buffer_load_dwordx4 v14, s[36:39], s46 offen  lds
    s_add_u32 m0, s49, 69632
    s_mov_b32 s46, 98304
    buffer_load_dwordx4 v14, s[36:39], s46 offen  lds
    s_add_u32 m0, s49, 73728
    s_mov_b32 s46, 983040
    buffer_load_dwordx4 v14, s[36:39], s46 offen  lds
    s_add_u32 m0, s49, 77824
    s_mov_b32 s46, 1015808
    buffer_load_dwordx4 v14, s[36:39], s46 offen  lds
    s_add_u32 m0, s49, 81920
    s_mov_b32 s46, 131072
    buffer_load_dwordx4 v14, s[36:39], s46 offen  lds
    s_add_u32 m0, s49, 86016
    s_mov_b32 s46, 163840
    buffer_load_dwordx4 v14, s[36:39], s46 offen  lds
    s_add_u32 m0, s49, 90112
    s_mov_b32 s46, 1048576
    buffer_load_dwordx4 v14, s[36:39], s46 offen  lds
    s_add_u32 m0, s49, 94208
    s_mov_b32 s46, 1081344
    buffer_load_dwordx4 v14, s[36:39], s46 offen  lds
    s_add_u32 m0, s49, 98304
    s_mov_b32 s46, 196608
    buffer_load_dwordx4 v14, s[36:39], s46 offen  lds
    s_add_u32 m0, s49, 102400
    s_mov_b32 s46, 229376
    buffer_load_dwordx4 v14, s[36:39], s46 offen  lds
    s_add_u32 m0, s49, 106496
    s_mov_b32 s46, 1114112
    buffer_load_dwordx4 v14, s[36:39], s46 offen  lds
    s_add_u32 m0, s49, 110592
    s_mov_b32 s46, 1146880
    buffer_load_dwordx4 v14, s[36:39], s46 offen  lds
    s_add_u32 m0, s49, 114688
    s_mov_b32 s46, 262144
    buffer_load_dwordx4 v14, s[36:39], s46 offen  lds
    s_add_u32 m0, s49, 118784
    s_mov_b32 s46, 294912
    buffer_load_dwordx4 v14, s[36:39], s46 offen  lds
    s_add_u32 m0, s49, 122880
    s_mov_b32 s46, 1179648
    buffer_load_dwordx4 v14, s[36:39], s46 offen  lds
    s_add_u32 m0, s49, 126976
    s_mov_b32 s46, 1212416
    buffer_load_dwordx4 v14, s[36:39], s46 offen  lds
    s_barrier
    s_add_u32 m0, s49, 131072
    s_mov_b32 s46, 327680
    buffer_load_dwordx4 v14, s[36:39], s46 offen  lds
    s_add_u32 m0, s49, 135168
    s_mov_b32 s46, 360448
    buffer_load_dwordx4 v14, s[36:39], s46 offen  lds
    s_add_u32 m0, s49, 139264
    s_mov_b32 s46, 1245184
    buffer_load_dwordx4 v14, s[36:39], s46 offen  lds
    s_add_u32 m0, s49, 143360
    s_mov_b32 s46, 1277952
    buffer_load_dwordx4 v14, s[36:39], s46 offen  lds
    s_add_u32 m0, s49, 147456
    s_mov_b32 s46, 393216
    buffer_load_dwordx4 v14, s[36:39], s46 offen  lds
    s_add_u32 m0, s49, 151552
    s_mov_b32 s46, 425984
    buffer_load_dwordx4 v14, s[36:39], s46 offen  lds
    s_add_u32 m0, s49, 155648
    s_mov_b32 s46, 1310720
    buffer_load_dwordx4 v14, s[36:39], s46 offen  lds
    s_add_u32 m0, s49, 159744
    s_mov_b32 s46, 1343488
    buffer_load_dwordx4 v14, s[36:39], s46 offen  lds
    s_add_u32 m0, s49, 0
    s_mov_b32 s46, 458752
    buffer_load_dwordx4 v14, s[36:39], s46 offen  lds
    s_add_u32 m0, s49, 4096
    s_mov_b32 s46, 491520
    buffer_load_dwordx4 v14, s[36:39], s46 offen  lds
    s_add_u32 m0, s49, 8192
    s_mov_b32 s46, 1376256
    buffer_load_dwordx4 v14, s[36:39], s46 offen  lds
    s_add_u32 m0, s49, 12288
    s_mov_b32 s46, 1409024
    buffer_load_dwordx4 v14, s[36:39], s46 offen  lds
    s_add_u32 m0, s49, 16384
    s_mov_b32 s46, 524288
    buffer_load_dwordx4 v14, s[36:39], s46 offen  lds
    s_add_u32 m0, s49, 20480
    s_mov_b32 s46, 557056
    buffer_load_dwordx4 v14, s[36:39], s46 offen  lds
    s_add_u32 m0, s49, 24576
    s_mov_b32 s46, 1441792
    buffer_load_dwordx4 v14, s[36:39], s46 offen  lds
    s_add_u32 m0, s49, 28672
    s_mov_b32 s46, 1474560
    buffer_load_dwordx4 v14, s[36:39], s46 offen  lds
    s_add_u32 m0, s49, 32768
    s_mov_b32 s46, 589824
    buffer_load_dwordx4 v14, s[36:39], s46 offen  lds
    s_add_u32 m0, s49, 36864
    s_mov_b32 s46, 622592
    buffer_load_dwordx4 v14, s[36:39], s46 offen  lds
    s_add_u32 m0, s49, 40960
    s_mov_b32 s46, 1507328
    buffer_load_dwordx4 v14, s[36:39], s46 offen  lds
    s_add_u32 m0, s49, 45056
    s_mov_b32 s46, 1540096
    buffer_load_dwordx4 v14, s[36:39], s46 offen  lds
    s_barrier
    s_waitcnt vmcnt(0)
    s_barrier
    s_barrier
    s_add_u32 s46, s49, 49152
    v_add_u32 v84, s46, v13
    ds_write_b128 v84, v[20:23] offset:0
    ds_write_b128 v84, v[24:27] offset:4096
    ds_write_b128 v84, v[28:31] offset:8192
    ds_write_b128 v84, v[32:35] offset:12288
    s_add_u32 s46, s49, 65536
    v_add_u32 v84, s46, v13
    ds_write_b128 v84, v[36:39] offset:0
    ds_write_b128 v84, v[40:43] offset:4096
    ds_write_b128 v84, v[44:47] offset:8192
    ds_write_b128 v84, v[48:51] offset:12288
    s_add_u32 s46, s49, 81920
    v_add_u32 v84, s46, v13
    ds_write_b128 v84, v[52:55] offset:0
    ds_write_b128 v84, v[56:59] offset:4096
    ds_write_b128 v84, v[60:63] offset:8192
    ds_write_b128 v84, v[64:67] offset:12288
    s_add_u32 s46, s49, 98304
    v_add_u32 v84, s46, v13
    ds_write_b128 v84, v[68:71] offset:0
    ds_write_b128 v84, v[72:75] offset:4096
    ds_write_b128 v84, v[76:79] offset:8192
    ds_write_b128 v84, v[80:83] offset:12288
    s_waitcnt lgkmcnt(0)
    s_barrier
    s_barrier
F_done:
    s_endpgm

.text
.fill 64, 4, 0xbf800000

.section .rodata,"a"
.p2align 6
.amdhsa_kernel ka_kernel
  .amdhsa_next_free_vgpr 220
  .amdhsa_next_free_sgpr 68
  .amdhsa_accum_offset 220
  .amdhsa_group_segment_fixed_size 0
  .amdhsa_kernarg_size 80
  .amdhsa_user_sgpr_count 2
  .amdhsa_user_sgpr_kernarg_segment_ptr 1
  .amdhsa_system_sgpr_workgroup_id_x 1
  .amdhsa_float_denorm_mode_32 3
.end_amdhsa_kernel

.section .rodata,"a"
.p2align 6
.amdhsa_kernel kb_kernel
  .amdhsa_next_free_vgpr 232
  .amdhsa_next_free_sgpr 43
  .amdhsa_accum_offset 232
  .amdhsa_group_segment_fixed_size 0
  .amdhsa_kernarg_size 80
  .amdhsa_user_sgpr_count 2
  .amdhsa_user_sgpr_kernarg_segment_ptr 1
  .amdhsa_system_sgpr_workgroup_id_x 1
  .amdhsa_float_denorm_mode_32 3
.end_amdhsa_kernel

.section .rodata,"a"
.p2align 6
.amdhsa_kernel sequential_preLN__spectral_gfnet__glu_gated_reglu__prompt_kernel
  .amdhsa_next_free_vgpr 244
  .amdhsa_next_free_sgpr 63
  .amdhsa_accum_offset 184
  .amdhsa_group_segment_fixed_size 0
  .amdhsa_kernarg_size 80
  .amdhsa_user_sgpr_count 2
  .amdhsa_user_sgpr_kernarg_segment_ptr 1
  .amdhsa_system_sgpr_workgroup_id_x 1
  .amdhsa_float_denorm_mode_32 3
.end_amdhsa_kernel
```
